```python
import torch

def _softmax(x, axis=-1):
    return torch.softmax(x, dim=axis)
def _gelu(x):
    return torch.nn.functional.gelu(x, approximate="tanh")
def _silu(x):
    return torch.nn.functional.silu(x)
def _sigmoid(x):
    return torch.sigmoid(x)
def _layernorm(x, axis=-1, eps=1e-5):
    m = x.mean(dim=axis, keepdim=True)
    v = x.var(dim=axis, keepdim=True, unbiased=False)
    return (x - m) / torch.sqrt(v + eps)
def _scatter_add(tgt, idx, src, axis=0):
    return tgt.clone().index_add_(axis, idx, src)
def _segment_sum(src, seg, n):
    out = torch.zeros((n,) + src.shape[1:], dtype=src.dtype)
    return out.index_add_(0, seg, src)
def _pad(x, pw):
    flat = tuple(v for pair in reversed(pw) for v in pair)
    return torch.nn.functional.pad(x, flat)

kernel_name = 'recurrent_scan__mha_block_cached__glu_gated_bilinear__decode'

def setup_inputs():

    _w = (lambda a: (lambda t: t.to(torch.bfloat16) if t.is_floating_point() else t)(torch.as_tensor(a)))
    def _A_setup():
        B, Sq, D = 4, 1, 448
        H, Sk, Dh = 16, 4096, 256
        return {
            "x": _w((lambda *s: torch.randn(*s, dtype=torch.bfloat16) * 0.2)(B, Sq, D)),
            "k_cache": _w((lambda *s: torch.randn(*s, dtype=torch.bfloat16) * 1.6)(B, H, Sk, Dh)),
            "v_cache": _w((lambda *s: torch.randn(*s, dtype=torch.bfloat16) * 1.6)(B, H, Sk, Dh)),
            "wq": _w((lambda *s: torch.randn(*s, dtype=torch.bfloat16) * 1.6)(D, H * Dh) * (D ** -0.5)),
            "wo": _w((lambda *s: torch.randn(*s, dtype=torch.bfloat16) * 1.6)(H * Dh, D) * ((H * Dh) ** -0.5)),
        }
    _A_in = _A_setup()

    def _B_setup():
        B, S, D, F = 4, 1, 448, 1792
        return {
            "x": _w((lambda *s: torch.randn(*s, dtype=torch.bfloat16) * 0.2)(B, S, D)),
            "w_gate": _w((lambda *s: torch.randn(*s, dtype=torch.bfloat16) * 0.8)(D, F) * (D ** -0.5)),
            "w_up": _w((lambda *s: torch.randn(*s, dtype=torch.bfloat16) * 0.8)(D, F) * (D ** -0.5)),
            "w_down": _w((lambda *s: torch.randn(*s, dtype=torch.bfloat16) * 0.8)(F, D) * (F ** -0.5)),
        }
    _B_in = _B_setup()

    return {
        "A_x": _A_in["x"],
        "A_k_cache": _A_in["k_cache"],
        "A_v_cache": _A_in["v_cache"],
        "A_wq": _A_in["wq"],
        "A_wo": _A_in["wo"],
        "B_x": _B_in["x"],
        "B_w_gate": _B_in["w_gate"],
        "B_w_up": _B_in["w_up"],
        "B_w_down": _B_in["w_down"],
    }

def reference(A_x, A_k_cache, A_v_cache, A_wq, A_wo, B_x, B_w_gate, B_w_up, B_w_down):
    def _A_ref(x, k_cache, v_cache, wq, wo):
        B, Sq, D = x.shape
        H, Dh = 16, 256
        q = (lambda x, *d: x.permute(*d))((x @ wq).reshape(B, Sq, H, Dh), 0, 2, 1, 3)
        scores = torch.einsum("bhqd,bhkd->bhqk", q, k_cache) * (Dh ** -0.5)
        p = _softmax(scores, axis=-1)
        o = torch.einsum("bhqk,bhkd->bhqd", p, v_cache)
        return (lambda x, *d: x.permute(*d))(o, 0, 2, 1, 3).reshape(B, Sq, H * Dh) @ wo

    def _B_ref(x, w_gate, w_up, w_down):
        g = torch.einsum("bsd,df->bsf", x, w_gate)
        u = torch.einsum("bsd,df->bsf", x, w_up)
        h = g * u
        return torch.einsum("bsf,fd->bsd", h, w_down)

    x = A_x
    xn = _layernorm(x, axis=-1)
    s = _A_ref(xn, A_k_cache, A_v_cache, A_wq, A_wo)
    g = _silu(_B_ref(xn, B_w_gate, B_w_up, B_w_down))
    return x + s * g
```

```asm
; @launch grid=(256,1,1) block=(256,1,1) lds=162880
.amdgcn_target "amdgcn-amd-amdhsa--gfx950"
.text
.globl recurrent_scan__mha_block_cached__glu_gated_bilinear__decode_kernel
.p2align 8
.type recurrent_scan__mha_block_cached__glu_gated_bilinear__decode_kernel,@function
recurrent_scan__mha_block_cached__glu_gated_bilinear__decode_kernel:
    s_cmp_ge_u32 s2, 256
    s_cbranch_scc1 L_end
    s_load_dwordx16 s[64:79], s[0:1], 0
    s_load_dwordx8 s[80:87], s[0:1], 64
    v_lshrrev_b32 v1, 6, v0
    s_nop 0
    v_readfirstlane_b32 s3, v1
    v_and_b32 v1, 63, v0
    s_and_b32 s5, s2, 15
    s_bfe_u32 s4, s2, 0x20004
    s_lshr_b32 s6, s2, 6
    s_lshl_b32 s7, s4, 4
    s_add_u32 s7, s7, s5
    s_lshl_b32 s7, s7, 2
    s_add_u32 s7, s7, s6
    s_lshl_b32 s7, s7, 19
    s_lshl_b32 s60, s3, 12
    s_add_u32 s7, s7, s60
    s_mul_i32 s61, s3, 38016
    s_add_u32 s61, s61, 10816
    s_lshl_b32 s62, s5, 9
    s_lshl_b32 s60, s3, 7
    s_add_u32 s62, s62, s60
    v_lshlrev_b32 v16, 4, v1
    v_and_b32 v20, 7, v1
    v_lshrrev_b32 v21, 3, v1
    v_bfe_u32 v22, v1, 2, 2
    v_lshlrev_b32 v2, 9, v22
    v_lshrrev_b32 v22, 4, v1
    v_lshl_add_u32 v2, v22, 6, v2
    v_and_b32 v22, 3, v1
    v_lshl_add_u32 v2, v22, 4, v2
    v_and_b32 v22, 3, v21
    v_lshrrev_b32 v23, 2, v21
    v_lshl_add_u32 v22, v23, 3, v22
    v_lshrrev_b32 v23, 1, v21
    v_lshlrev_b32 v23, 1, v23
    v_xor_b32 v23, v23, v20
    v_lshlrev_b32 v23, 4, v23
    v_lshl_add_u32 v4, v22, 13, v23
    v_mul_u32_u24 v5, 3584, v22
    v_add_u32 v5, v5, v23
    v_cmp_gt_u32 vcc, 56, v1
    v_bfrev_b32 v24, 1
    s_nop 0
    v_cndmask_b32 v24, v24, v16, vcc
    s_add_u32 s90, s4, s3
    s_and_b32 s90, s90, 3
    s_mul_i32 s90, s90, 896
    s_waitcnt lgkmcnt(0)
    s_mov_b32 s8, s64
    s_mov_b32 s9, s65
    s_mov_b32 s10, 3584
    s_mov_b32 s11, 0x20000
    s_mov_b32 s12, s66
    s_mov_b32 s13, s67
    s_mov_b32 s14, 134217728
    s_mov_b32 s15, 0x20000
    s_mov_b32 s20, s70
    s_mov_b32 s21, s71
    s_mov_b32 s22, 3670016
    s_mov_b32 s23, 0x20000
    s_add_u32 s101, s7, 0
    buffer_load_dwordx4 v[32:35], v2, s[12:15], s101 offen offset:0 nt
    buffer_load_dwordx4 v[36:39], v2, s[12:15], s101 offen offset:256 nt
    buffer_load_dwordx4 v[40:43], v2, s[12:15], s101 offen offset:2048 nt
    buffer_load_dwordx4 v[44:47], v2, s[12:15], s101 offen offset:2304 nt
    buffer_load_dwordx4 v[20:23], v24, s[8:11], s90 offen nt
    s_add_u32 s101, s7, 16384
    buffer_load_dwordx4 v[48:51], v2, s[12:15], s101 offen offset:0 nt
    s_add_u32 m0, s61, 25344
    s_add_u32 s60, s62, 0
    buffer_load_dwordx4 v4, s[20:23], s60 offen lds
    buffer_load_dwordx4 v[52:55], v2, s[12:15], s101 offen offset:256 nt
    buffer_load_dwordx4 v[56:59], v2, s[12:15], s101 offen offset:2048 nt
    s_add_u32 m0, s61, 26400
    s_add_u32 s60, s62, 131072
    buffer_load_dwordx4 v4, s[20:23], s60 offen lds
    buffer_load_dwordx4 v[60:63], v2, s[12:15], s101 offen offset:2304 nt
    s_add_u32 m0, s61, 27456
    s_add_u32 s60, s62, 32768
    buffer_load_dwordx4 v4, s[20:23], s60 offen lds
    s_add_u32 s101, s7, 32768
    buffer_load_dwordx4 v[64:67], v2, s[12:15], s101 offen offset:0 nt
    buffer_load_dwordx4 v[68:71], v2, s[12:15], s101 offen offset:256 nt
    s_add_u32 m0, s61, 28512
    s_add_u32 s60, s62, 163840
    buffer_load_dwordx4 v4, s[20:23], s60 offen lds
    buffer_load_dwordx4 v[72:75], v2, s[12:15], s101 offen offset:2048 nt
    s_add_u32 m0, s61, 29568
    s_add_u32 s60, s62, 262144
    buffer_load_dwordx4 v4, s[20:23], s60 offen lds
    buffer_load_dwordx4 v[76:79], v2, s[12:15], s101 offen offset:2304 nt
    s_mov_b32 s16, s68
    s_mov_b32 s17, s69
    s_mov_b32 s18, 134217728
    s_mov_b32 s19, 0x20000
    s_mov_b32 s24, s72
    s_mov_b32 s25, s73
    s_mov_b32 s26, 3670016
    s_mov_b32 s27, 0x20000
    s_mov_b32 s36, s82
    s_mov_b32 s37, s83
    s_mov_b32 s38, 3584
    s_mov_b32 s39, 0x20000
    s_mov_b32 s40, s84
    s_mov_b32 s41, s85
    s_mov_b32 s43, 0x20000
    s_cmp_eq_u32 s3, 0
    s_cselect_b32 s42, 256, 0
    s_mov_b32 s44, s86
    s_mov_b32 s45, s87
    s_mov_b32 s46, 4194304
    s_mov_b32 s47, 0x20000
    s_and_b32 s60, s2, 7
    s_cmp_eq_u32 s60, 7
    s_cselect_b32 s99, 32, s2
    s_cmp_lt_u32 s99, 32
    s_cselect_b32 s50, 4194304, 0
    s_cselect_b32 s58, 256, 0
    s_mov_b32 s48, s86
    s_mov_b32 s49, s87
    s_mov_b32 s51, 0x20000
    s_mov_b32 s56, s84
    s_mov_b32 s57, s85
    s_mov_b32 s59, 0x20000
    s_sub_u32 s98, s2, 200
    s_cmp_lt_u32 s98, 56
    s_cselect_b32 s98, s98, 0
    s_cselect_b32 s34, 1605632, 0
    s_cselect_b32 s54, 4194304, 0
    s_cselect_b32 s58, 256, s58
    s_mov_b32 s32, s80
    s_mov_b32 s33, s81
    s_mov_b32 s35, 0x20000
    s_mov_b32 s52, s86
    s_mov_b32 s53, s87
    s_mov_b32 s55, 0x20000
    s_mul_i32 s90, s2, 2341
    s_lshr_b32 s90, s90, 16
    s_mul_i32 s60, s90, 28
    s_sub_u32 s60, s2, s60
    s_lshl_b32 s100, s60, 13
    s_lshl_b32 s91, s90, 9
    s_add_u32 s100, s100, s91
    s_add_u32 s100, s100, 2097152
    s_lshl_b32 s91, s3, 28
    s_add_u32 s100, s100, s91
    s_cmp_lt_u32 s90, 4
    s_cselect_b32 s28, s76, s78
    s_cselect_b32 s29, s77, s79
    s_mov_b32 s31, 0x20000
    s_cmp_lt_u32 s2, 224
    s_cselect_b32 s30, 1605632, 0
    s_cselect_b32 s100, s100, 0x40000000
    s_and_b32 s90, s90, 3
    s_lshl_b32 s90, s90, 2
    s_add_u32 s90, s90, s3
    s_mul_i32 s88, s90, 114688
    s_lshl_b32 s60, s60, 7
    s_add_u32 s88, s88, s60
    s_min_u32 s90, s90, 13
    s_lshl_b32 s90, s90, 6
    s_lshl_b32 s91, s3, 8
    s_mul_i32 s63, s5, 229376
    s_add_u32 s63, s63, s91
    s_mul_i32 s89, s98, 28672
    s_add_u32 s89, s89, s91
    s_lshl_b32 s92, s4, 2
    s_add_u32 s92, s92, s3
    s_lshl_b32 s92, s92, 15
    s_lshl_b32 s60, s5, 2
    s_add_u32 s60, s60, s6
    s_lshl_b32 s60, s60, 6
    s_add_u32 s92, s92, s60
    s_and_b32 s60, s2, 31
    s_lshr_b32 s97, s60, 3
    s_lshl_b32 s60, s60, 2
    s_add_u32 s60, s60, s3
    s_lshl_b32 s95, s60, 12
    s_add_u32 s96, s95, 524288
    s_lshl_b32 s97, s97, 9
    s_add_u32 s97, s97, 1572864
    s_mov_b32 s94, 0x3db8aa3b
    v_lshrrev_b32 v25, 4, v1
    v_bfe_u32 v26, v1, 2, 2
    v_and_b32 v27, 3, v1
    v_lshrrev_b32 v28, 5, v1
    v_lshlrev_b32 v28, 5, v28
    v_xor_b32 v3, v28, v16
    v_and_b32 v28, 1, v25
    v_lshlrev_b32 v29, 3, v28
    v_and_b32 v30, 15, v1
    v_xor_b32 v29, v29, v30
    v_lshlrev_b32 v29, 4, v29
    v_add_u32 v30, s91, v29
    v_cmp_gt_u32 vcc, 896, v30
    v_mul_u32_u24 v6, 896, v25
    v_add_u32 v6, v6, v29
    v_bfrev_b32 v29, 1
    v_cndmask_b32 v6, v29, v6, vcc
    v_lshl_add_u32 v29, v28, 2, v26
    v_lshrrev_b32 v30, 1, v25
    v_mul_u32_u24 v30, 1056, v30
    v_lshl_add_u32 v30, v29, 7, v30
    v_lshl_add_u32 v30, v27, 3, v30
    v_add_u32 v30, s61, v30
    v_lshrrev_b32 v29, 1, v29
    v_xor_b32 v31, 0, v29
    v_lshl_add_u32 v7, v31, 5, v30
    v_xor_b32 v31, 1, v29
    v_lshl_add_u32 v8, v31, 5, v30
    v_xor_b32 v31, 2, v29
    v_lshl_add_u32 v9, v31, 5, v30
    v_xor_b32 v31, 3, v29
    v_lshl_add_u32 v10, v31, 5, v30
    v_mul_u32_u24 v30, 1056, v26
    v_lshl_add_u32 v30, v25, 8, v30
    v_lshl_add_u32 v30, v27, 3, v30
    v_add_u32 v30, s61, v30
    v_lshlrev_b32 v31, 7, v28
    v_add_u32 v11, v30, v31
    v_sub_u32 v12, v30, v31
    v_lshrrev_b32 v30, 1, v25
    v_lshl_add_u32 v30, v26, 1, v30
    v_mul_u32_u24 v30, 1056, v30
    v_lshl_add_u32 v30, v28, 9, v30
    v_lshl_add_u32 v30, v27, 3, v30
    v_add_u32 v30, s61, v30
    v_lshlrev_b32 v31, 5, v28
    v_add_u32 v13, v30, v31
    v_sub_u32 v14, v30, v31
    v_mul_u32_u24 v15, 960, v27
    v_lshl_add_u32 v15, v25, 4, v15
    v_subrev_u32 v30, s4, v1
    v_and_b32 v30, 3, v30
    v_mul_u32_u24 v17, 960, v30
    v_lshl_add_u32 v17, v25, 4, v17
    v_add_u32 v17, s90, v17
    v_mov_b32 v18, 0xff800000
    v_mov_b32 v0, 0xff800000
    s_waitcnt vmcnt(17)
    s_add_u32 s101, s7, 49152
    buffer_load_dwordx4 v[80:83], v2, s[12:15], s101 offen offset:0 nt
    s_add_u32 m0, s61, 30624
    s_add_u32 s60, s62, 393216
    buffer_load_dwordx4 v4, s[20:23], s60 offen lds
    s_waitcnt vmcnt(18)
    buffer_load_dwordx4 v[84:87], v2, s[12:15], s101 offen offset:256 nt
    s_add_u32 m0, s61, 31680
    s_add_u32 s60, s62, 294912
    buffer_load_dwordx4 v4, s[20:23], s60 offen lds
    s_waitcnt vmcnt(19)
    buffer_load_dwordx4 v[88:91], v2, s[12:15], s101 offen offset:2048 nt
    s_waitcnt vmcnt(19)
    buffer_load_dwordx4 v[92:95], v2, s[12:15], s101 offen offset:2304 nt
    s_add_u32 m0, s61, 32736
    s_add_u32 s60, s62, 425984
    buffer_load_dwordx4 v4, s[20:23], s60 offen lds
    s_waitcnt vmcnt(19)
    s_add_u32 s101, s7, 65536
    buffer_load_dwordx4 v[96:99], v2, s[12:15], s101 offen offset:0 nt
    s_add_u32 m0, s61, 33792
    s_add_u32 s60, s88, 0
    buffer_load_dwordx4 v5, s[28:31], s60 offen lds
    v_lshlrev_b32 v192, 16, v20
    v_and_b32 v193, 0xffff0000, v20
    v_lshlrev_b32 v194, 16, v21
    v_and_b32 v195, 0xffff0000, v21
    v_lshlrev_b32 v196, 16, v22
    v_and_b32 v197, 0xffff0000, v22
    v_lshlrev_b32 v198, 16, v23
    v_and_b32 v199, 0xffff0000, v23
    v_add_f32 v200, v192, v193
    v_add_f32 v201, v194, v195
    v_add_f32 v202, v196, v197
    v_add_f32 v203, v198, v199
    v_add_f32 v200, v200, v201
    v_add_f32 v202, v202, v203
    v_add_f32 v200, v200, v202
    s_nop 1
    v_add_f32_dpp v200, v200, v200 row_ror:1 row_mask:0xf bank_mask:0xf
    s_nop 1
    v_add_f32_dpp v200, v200, v200 row_ror:2 row_mask:0xf bank_mask:0xf
    s_nop 1
    v_add_f32_dpp v200, v200, v200 row_ror:4 row_mask:0xf bank_mask:0xf
    s_nop 1
    v_add_f32_dpp v200, v200, v200 row_ror:8 row_mask:0xf bank_mask:0xf
    v_mov_b32 v201, v200
    s_nop 1
    v_permlane16_swap_b32 v201, v200
    v_add_f32 v200, v200, v201
    v_mov_b32 v201, v200
    s_nop 1
    v_permlane32_swap_b32 v201, v200
    v_add_f32 v200, v200, v201
    v_mul_f32 v200, 0x3b124925, v200
    v_sub_f32 v202, v192, v200
    v_mul_f32 v203, v202, v202
    v_sub_f32 v202, v193, v200
    v_fmac_f32 v203, v202, v202
    v_sub_f32 v202, v194, v200
    v_fmac_f32 v203, v202, v202
    v_sub_f32 v202, v195, v200
    v_fmac_f32 v203, v202, v202
    v_sub_f32 v202, v196, v200
    v_fmac_f32 v203, v202, v202
    v_sub_f32 v202, v197, v200
    v_fmac_f32 v203, v202, v202
    v_sub_f32 v202, v198, v200
    v_fmac_f32 v203, v202, v202
    v_sub_f32 v202, v199, v200
    v_fmac_f32 v203, v202, v202
    v_cmp_gt_u32 vcc, 56, v1
    s_nop 1
    v_cndmask_b32 v203, 0, v203, vcc
    s_nop 1
    v_add_f32_dpp v203, v203, v203 row_ror:1 row_mask:0xf bank_mask:0xf
    s_nop 1
    v_add_f32_dpp v203, v203, v203 row_ror:2 row_mask:0xf bank_mask:0xf
    s_nop 1
    v_add_f32_dpp v203, v203, v203 row_ror:4 row_mask:0xf bank_mask:0xf
    s_nop 1
    v_add_f32_dpp v203, v203, v203 row_ror:8 row_mask:0xf bank_mask:0xf
    v_mov_b32 v201, v203
    s_nop 1
    v_permlane16_swap_b32 v201, v203
    v_add_f32 v203, v203, v201
    v_mov_b32 v201, v203
    s_nop 1
    v_permlane32_swap_b32 v201, v203
    v_add_f32 v203, v203, v201
    v_mul_f32 v203, 0x3b124925, v203
    v_cvt_pk_bf16_f32 v200, v200, v200
    v_and_b32 v200, 0xffff0000, v200
    v_cvt_pk_bf16_f32 v203, v203, v203
    v_and_b32 v203, 0xffff0000, v203
    v_add_f32 v203, 0x3727c5ac, v203
    v_cvt_pk_bf16_f32 v203, v203, v203
    v_and_b32 v203, 0xffff0000, v203
    v_sqrt_f32 v203, v203
    s_nop 0
    v_cvt_pk_bf16_f32 v203, v203, v203
    v_and_b32 v203, 0xffff0000, v203
    v_rcp_f32 v204, v203
    v_sub_f32 v192, v192, v200
    v_sub_f32 v193, v193, v200
    v_sub_f32 v194, v194, v200
    v_sub_f32 v195, v195, v200
    v_sub_f32 v196, v196, v200
    v_sub_f32 v197, v197, v200
    v_sub_f32 v198, v198, v200
    v_sub_f32 v199, v199, v200
    v_cvt_pk_bf16_f32 v20, v192, v193
    v_lshlrev_b32 v192, 16, v20
    v_and_b32 v193, 0xffff0000, v20
    v_cvt_pk_bf16_f32 v21, v194, v195
    v_lshlrev_b32 v194, 16, v21
    v_and_b32 v195, 0xffff0000, v21
    v_cvt_pk_bf16_f32 v22, v196, v197
    v_lshlrev_b32 v196, 16, v22
    v_and_b32 v197, 0xffff0000, v22
    v_cvt_pk_bf16_f32 v23, v198, v199
    v_lshlrev_b32 v198, 16, v23
    v_and_b32 v199, 0xffff0000, v23
    v_mul_f32 v205, v192, v204
    v_fma_f32 v206, -v205, v203, v192
    v_fma_f32 v192, v206, v204, v205
    v_mul_f32 v205, v193, v204
    v_fma_f32 v206, -v205, v203, v193
    v_fma_f32 v193, v206, v204, v205
    v_mul_f32 v205, v194, v204
    v_fma_f32 v206, -v205, v203, v194
    v_fma_f32 v194, v206, v204, v205
    v_mul_f32 v205, v195, v204
    v_fma_f32 v206, -v205, v203, v195
    v_fma_f32 v195, v206, v204, v205
    v_mul_f32 v205, v196, v204
    v_fma_f32 v206, -v205, v203, v196
    v_fma_f32 v196, v206, v204, v205
    v_mul_f32 v205, v197, v204
    v_fma_f32 v206, -v205, v203, v197
    v_fma_f32 v197, v206, v204, v205
    v_mul_f32 v205, v198, v204
    v_fma_f32 v206, -v205, v203, v198
    v_fma_f32 v198, v206, v204, v205
    v_mul_f32 v205, v199, v204
    v_fma_f32 v206, -v205, v203, v199
    v_fma_f32 v199, v206, v204, v205
    v_cvt_pk_bf16_f32 v20, v192, v193
    v_cvt_pk_bf16_f32 v21, v194, v195
    v_cvt_pk_bf16_f32 v22, v196, v197
    v_cvt_pk_bf16_f32 v23, v198, v199
    s_mul_i32 s90, s3, 960
    v_add_u32 v24, s90, v16
    s_mov_b32 exec_hi, 0x00ffffff
    ds_write_b128 v24, v[20:23] offset:0
    s_mov_b32 exec_hi, -1
    s_waitcnt lgkmcnt(0)
    s_barrier
    s_waitcnt vmcnt(19)
    buffer_load_dwordx4 v[100:103], v2, s[12:15], s101 offen offset:256 nt
    s_waitcnt vmcnt(19)
    buffer_load_dwordx4 v[104:107], v2, s[12:15], s101 offen offset:2048 nt
    s_add_u32 m0, s61, 34848
    s_add_u32 s60, s88, 57344
    buffer_load_dwordx4 v5, s[28:31], s60 offen lds
    s_waitcnt vmcnt(19)
    buffer_load_dwordx4 v[108:111], v2, s[12:15], s101 offen offset:2304 nt
    s_waitcnt vmcnt(18)
    s_add_u32 s101, s7, 81920
    buffer_load_dwordx4 v[112:115], v2, s[12:15], s101 offen offset:0 nt
    s_add_u32 m0, s61, 35904
    s_add_u32 s60, s88, 14336
    buffer_load_dwordx4 v5, s[28:31], s60 offen lds
    s_waitcnt vmcnt(19)
    buffer_load_dwordx4 v[116:119], v2, s[12:15], s101 offen offset:256 nt
    s_add_u32 m0, s61, 36960
    s_add_u32 s60, s88, 71680
    buffer_load_dwordx4 v5, s[28:31], s60 offen lds
    s_waitcnt vmcnt(19)
    buffer_load_dwordx4 v[120:123], v2, s[12:15], s101 offen offset:2048 nt
    ds_read_b128 v[28:31], v15 offset:0
    ds_read_b64_tr_b16 v[240:241], v7 offset:25344
    ds_read_b64_tr_b16 v[242:243], v7 offset:27456
    ds_read_b64_tr_b16 v[244:245], v8 offset:25344
    ds_read_b64_tr_b16 v[246:247], v8 offset:27456
    ds_read_b64_tr_b16 v[248:249], v9 offset:25344
    ds_read_b64_tr_b16 v[250:251], v9 offset:27456
    ds_read_b64_tr_b16 v[252:253], v10 offset:25344
    ds_read_b64_tr_b16 v[254:255], v10 offset:27456
    s_waitcnt lgkmcnt(6)
    v_mfma_f32_16x16x32_bf16 v[176:179], v[28:31], v[240:243], 0
    s_waitcnt lgkmcnt(4)
    v_mfma_f32_16x16x32_bf16 v[180:183], v[28:31], v[244:247], 0
    s_waitcnt lgkmcnt(2)
    v_mfma_f32_16x16x32_bf16 v[184:187], v[28:31], v[248:251], 0
    s_waitcnt lgkmcnt(0)
    v_mfma_f32_16x16x32_bf16 v[188:191], v[28:31], v[252:255], 0
    s_waitcnt vmcnt(18)
    buffer_load_dwordx4 v[124:127], v2, s[12:15], s101 offen offset:2304 nt
    s_add_u32 m0, s61, 25344
    s_add_u32 s60, s62, 524288
    buffer_load_dwordx4 v4, s[20:23], s60 offen lds
    s_waitcnt vmcnt(19)
    s_add_u32 s101, s7, 98304
    buffer_load_dwordx4 v[128:131], v2, s[12:15], s101 offen offset:0 nt
    s_add_u32 m0, s61, 26400
    s_add_u32 s60, s62, 655360
    buffer_load_dwordx4 v4, s[20:23], s60 offen lds
    s_waitcnt vmcnt(19)
    buffer_load_dwordx4 v[132:135], v2, s[12:15], s101 offen offset:256 nt
    s_waitcnt vmcnt(18)
    buffer_load_dwordx4 v[136:139], v2, s[12:15], s101 offen offset:2048 nt
    s_add_u32 m0, s61, 27456
    s_add_u32 s60, s62, 557056
    buffer_load_dwordx4 v4, s[20:23], s60 offen lds
    s_waitcnt vmcnt(19)
    buffer_load_dwordx4 v[140:143], v2, s[12:15], s101 offen offset:2304 nt
    s_add_u32 m0, s61, 28512
    s_add_u32 s60, s62, 688128
    buffer_load_dwordx4 v4, s[20:23], s60 offen lds
    s_waitcnt vmcnt(19)
    s_add_u32 s101, s7, 114688
    buffer_load_dwordx4 v[144:147], v2, s[12:15], s101 offen offset:0 nt
    ds_read_b128 v[28:31], v15 offset:64
    ds_read_b64_tr_b16 v[240:241], v7 offset:29568
    ds_read_b64_tr_b16 v[242:243], v7 offset:31680
    ds_read_b64_tr_b16 v[244:245], v8 offset:29568
    ds_read_b64_tr_b16 v[246:247], v8 offset:31680
    ds_read_b64_tr_b16 v[248:249], v9 offset:29568
    ds_read_b64_tr_b16 v[250:251], v9 offset:31680
    ds_read_b64_tr_b16 v[252:253], v10 offset:29568
    ds_read_b64_tr_b16 v[254:255], v10 offset:31680
    s_waitcnt lgkmcnt(6)
    v_mfma_f32_16x16x32_bf16 v[176:179], v[28:31], v[240:243], v[176:179]
    s_waitcnt lgkmcnt(4)
    v_mfma_f32_16x16x32_bf16 v[180:183], v[28:31], v[244:247], v[180:183]
    s_waitcnt lgkmcnt(2)
    v_mfma_f32_16x16x32_bf16 v[184:187], v[28:31], v[248:251], v[184:187]
    s_waitcnt lgkmcnt(0)
    v_mfma_f32_16x16x32_bf16 v[188:191], v[28:31], v[252:255], v[188:191]
    s_waitcnt vmcnt(18)
    buffer_load_dwordx4 v[148:151], v2, s[12:15], s101 offen offset:256 nt
    s_add_u32 m0, s61, 29568
    s_add_u32 s60, s62, 786432
    buffer_load_dwordx4 v4, s[20:23], s60 offen lds
    s_waitcnt vmcnt(19)
    buffer_load_dwordx4 v[152:155], v2, s[12:15], s101 offen offset:2048 nt
    s_waitcnt vmcnt(18)
    buffer_load_dwordx4 v[156:159], v2, s[12:15], s101 offen offset:2304 nt
    s_add_u32 m0, s61, 30624
    s_add_u32 s60, s62, 917504
    buffer_load_dwordx4 v4, s[20:23], s60 offen lds
    s_waitcnt vmcnt(19)
    s_add_u32 s101, s7, 131072
    buffer_load_dwordx4 a[0:3], v2, s[12:15], s101 offen offset:0 nt
    s_add_u32 m0, s61, 31680
    s_add_u32 s60, s62, 819200
    buffer_load_dwordx4 v4, s[20:23], s60 offen lds
    s_waitcnt vmcnt(19)
    buffer_load_dwordx4 a[4:7], v2, s[12:15], s101 offen offset:256 nt
    s_waitcnt vmcnt(18)
    buffer_load_dwordx4 a[8:11], v2, s[12:15], s101 offen offset:2048 nt
    s_add_u32 m0, s61, 32736
    s_add_u32 s60, s62, 950272
    buffer_load_dwordx4 v4, s[20:23], s60 offen lds
    ds_read_b128 v[28:31], v17 offset:0
    ds_read_b64_tr_b16 v[240:241], v7 offset:33792
    ds_read_b64_tr_b16 v[242:243], v7 offset:35904
    ds_read_b64_tr_b16 v[244:245], v8 offset:33792
    ds_read_b64_tr_b16 v[246:247], v8 offset:35904
    ds_read_b64_tr_b16 v[248:249], v9 offset:33792
    ds_read_b64_tr_b16 v[250:251], v9 offset:35904
    ds_read_b64_tr_b16 v[252:253], v10 offset:33792
    ds_read_b64_tr_b16 v[254:255], v10 offset:35904
    s_waitcnt lgkmcnt(6)
    v_mfma_f32_16x16x32_bf16 v[224:227], v[28:31], v[240:243], 0
    s_waitcnt lgkmcnt(4)
    v_mfma_f32_16x16x32_bf16 v[228:231], v[28:31], v[244:247], 0
    s_waitcnt lgkmcnt(2)
    v_mfma_f32_16x16x32_bf16 v[232:235], v[28:31], v[248:251], 0
    s_waitcnt lgkmcnt(0)
    v_mfma_f32_16x16x32_bf16 v[236:239], v[28:31], v[252:255], 0
    s_lshl_b32 s90, s3, 10
    v_add_u32 v24, s90, v16
    s_mov_b64 exec, 0xffff
    ds_write_b128 v24, v[224:227] offset:4416
    ds_write_b128 v24, v[228:231] offset:4672
    s_nop 0
    ds_write_b128 v24, v[232:235] offset:4928
    s_nop 0
    ds_write_b128 v24, v[236:239] offset:5184
    s_mov_b64 exec, -1
    s_waitcnt vmcnt(19)
    buffer_load_dwordx4 a[12:15], v2, s[12:15], s101 offen offset:2304 nt
    s_add_u32 m0, s61, 33792
    s_add_u32 s60, s62, 1048576
    buffer_load_dwordx4 v4, s[20:23], s60 offen lds
    s_waitcnt vmcnt(19)
    s_add_u32 s101, s7, 147456
    buffer_load_dwordx4 a[16:19], v2, s[12:15], s101 offen offset:0 nt
    v_mov_b32 v20, -1
    v_mov_b32 v21, -1
    v_mov_b32 v22, -1
    v_mov_b32 v23, -1
    buffer_store_dwordx4 v[20:23], v16, s[48:51], s95 offen offset:0 sc1
    buffer_store_dwordx4 v[20:23], v16, s[48:51], s95 offen offset:1024 sc1
    buffer_store_dwordx4 v[20:23], v16, s[48:51], s95 offen offset:2048 sc1
    buffer_store_dwordx4 v[20:23], v16, s[48:51], s95 offen offset:3072 sc1
    buffer_store_dwordx4 v[20:23], v16, s[48:51], s96 offen offset:0 sc1
    buffer_store_dwordx4 v[20:23], v16, s[48:51], s96 offen offset:1024 sc1
    buffer_store_dwordx4 v[20:23], v16, s[48:51], s96 offen offset:2048 sc1
    v_and_b32 v24, 0x1ff, v16
    s_lshl_b32 s90, s3, 28
    s_add_u32 s90, s90, s97
    buffer_store_dwordx4 v[20:23], v24, s[48:51], s90 offen sc1
    s_lshl_b32 s90, s98, 2
    s_add_u32 s90, s90, s3
    s_lshl_b32 s90, s90, 10
    s_add_u32 s90, s90, 2097152
    buffer_store_dwordx4 v[20:23], v16, s[52:55], s90 offen sc1
    v_cmp_gt_u32 vcc, 32, v1
    s_nop 1
    v_cndmask_b32 v24, 0, v20, vcc
    v_cndmask_b32 v25, 0, v21, vcc
    v_cndmask_b32 v26, 0, v22, vcc
    v_cndmask_b32 v27, 0, v23, vcc
    buffer_store_dwordx4 v[24:27], v16, s[48:51], s96 offen offset:3072 sc1
    s_waitcnt vmcnt(28)
    buffer_load_dwordx4 a[20:23], v2, s[12:15], s101 offen offset:256 nt
    s_add_u32 m0, s61, 34848
    s_add_u32 s60, s62, 1179648
    buffer_load_dwordx4 v4, s[20:23], s60 offen lds
    s_waitcnt vmcnt(29)
    buffer_load_dwordx4 a[24:27], v2, s[12:15], s101 offen offset:2048 nt
    s_add_u32 m0, s61, 35904
    s_add_u32 s60, s62, 1081344
    buffer_load_dwordx4 v4, s[20:23], s60 offen lds
    s_waitcnt vmcnt(29)
    buffer_load_dwordx4 a[28:31], v2, s[12:15], s101 offen offset:2304 nt
    s_waitcnt vmcnt(28)
    s_add_u32 s101, s7, 163840
    buffer_load_dwordx4 a[32:35], v2, s[12:15], s101 offen offset:0 nt
    s_add_u32 m0, s61, 36960
    s_add_u32 s60, s62, 1212416
    buffer_load_dwordx4 v4, s[20:23], s60 offen lds
    ds_read_b128 v[28:31], v15 offset:128
    ds_read_b64_tr_b16 v[240:241], v7 offset:25344
    ds_read_b64_tr_b16 v[242:243], v7 offset:27456
    ds_read_b64_tr_b16 v[244:245], v8 offset:25344
    ds_read_b64_tr_b16 v[246:247], v8 offset:27456
    ds_read_b64_tr_b16 v[248:249], v9 offset:25344
    ds_read_b64_tr_b16 v[250:251], v9 offset:27456
    ds_read_b64_tr_b16 v[252:253], v10 offset:25344
    ds_read_b64_tr_b16 v[254:255], v10 offset:27456
    s_waitcnt lgkmcnt(6)
    v_mfma_f32_16x16x32_bf16 v[176:179], v[28:31], v[240:243], v[176:179]
    s_waitcnt lgkmcnt(4)
    v_mfma_f32_16x16x32_bf16 v[180:183], v[28:31], v[244:247], v[180:183]
    s_waitcnt lgkmcnt(2)
    v_mfma_f32_16x16x32_bf16 v[184:187], v[28:31], v[248:251], v[184:187]
    s_waitcnt lgkmcnt(0)
    v_mfma_f32_16x16x32_bf16 v[188:191], v[28:31], v[252:255], v[188:191]
    s_waitcnt vmcnt(29)
    buffer_load_dwordx4 a[36:39], v2, s[12:15], s101 offen offset:256 nt
    s_add_u32 m0, s61, 25344
    s_add_u32 s60, s62, 1310720
    buffer_load_dwordx4 v4, s[20:23], s60 offen lds
    s_waitcnt vmcnt(29)
    buffer_load_dwordx4 a[40:43], v2, s[12:15], s101 offen offset:2048 nt
    s_waitcnt vmcnt(29)
    buffer_load_dwordx4 a[44:47], v2, s[12:15], s101 offen offset:2304 nt
    s_add_u32 m0, s61, 26400
    s_add_u32 s60, s62, 1441792
    buffer_load_dwordx4 v4, s[20:23], s60 offen lds
    s_waitcnt vmcnt(29)
    s_add_u32 s101, s7, 180224
    buffer_load_dwordx4 a[48:51], v2, s[12:15], s101 offen offset:0 nt
    s_waitcnt vmcnt(28)
    buffer_load_dwordx4 a[52:55], v2, s[12:15], s101 offen offset:256 nt
    s_add_u32 m0, s61, 27456
    s_add_u32 s60, s62, 1343488
    buffer_load_dwordx4 v4, s[20:23], s60 offen lds
    s_waitcnt vmcnt(29)
    buffer_load_dwordx4 a[56:59], v2, s[12:15], s101 offen offset:2048 nt
    s_add_u32 m0, s61, 28512
    s_add_u32 s60, s62, 1474560
    buffer_load_dwordx4 v4, s[20:23], s60 offen lds
    s_waitcnt vmcnt(29)
    buffer_load_dwordx4 a[60:63], v2, s[12:15], s101 offen offset:2304 nt
    ds_read_b128 v[28:31], v15 offset:192
    ds_read_b64_tr_b16 v[240:241], v7 offset:29568
    ds_read_b64_tr_b16 v[242:243], v7 offset:31680
    ds_read_b64_tr_b16 v[244:245], v8 offset:29568
    ds_read_b64_tr_b16 v[246:247], v8 offset:31680
    ds_read_b64_tr_b16 v[248:249], v9 offset:29568
    ds_read_b64_tr_b16 v[250:251], v9 offset:31680
    ds_read_b64_tr_b16 v[252:253], v10 offset:29568
    ds_read_b64_tr_b16 v[254:255], v10 offset:31680
    s_waitcnt lgkmcnt(6)
    v_mfma_f32_16x16x32_bf16 v[176:179], v[28:31], v[240:243], v[176:179]
    s_waitcnt lgkmcnt(4)
    v_mfma_f32_16x16x32_bf16 v[180:183], v[28:31], v[244:247], v[180:183]
    s_waitcnt lgkmcnt(2)
    v_mfma_f32_16x16x32_bf16 v[184:187], v[28:31], v[248:251], v[184:187]
    s_waitcnt lgkmcnt(0)
    v_mfma_f32_16x16x32_bf16 v[188:191], v[28:31], v[252:255], v[188:191]
    s_waitcnt vmcnt(28)
    s_add_u32 s101, s7, 196608
    buffer_load_dwordx4 a[64:67], v2, s[12:15], s101 offen offset:0 nt
    s_add_u32 m0, s61, 29568
    s_add_u32 s60, s62, 1572864
    buffer_load_dwordx4 v4, s[20:23], s60 offen lds
    s_waitcnt vmcnt(19)
    buffer_load_dwordx4 a[68:71], v2, s[12:15], s101 offen offset:256 nt
    s_add_u32 m0, s61, 30624
    s_add_u32 s60, s62, 1703936
    buffer_load_dwordx4 v4, s[20:23], s60 offen lds
    s_waitcnt vmcnt(19)
    buffer_load_dwordx4 a[72:75], v2, s[12:15], s101 offen offset:2048 nt
    s_waitcnt vmcnt(18)
    buffer_load_dwordx4 a[76:79], v2, s[12:15], s101 offen offset:2304 nt
    s_add_u32 m0, s61, 31680
    s_add_u32 s60, s62, 1605632
    buffer_load_dwordx4 v4, s[20:23], s60 offen lds
    s_waitcnt vmcnt(19)
    s_add_u32 s101, s7, 212992
    buffer_load_dwordx4 a[80:83], v2, s[12:15], s101 offen offset:0 nt
    s_add_u32 m0, s61, 32736
    s_add_u32 s60, s62, 1736704
    buffer_load_dwordx4 v4, s[20:23], s60 offen lds
    s_waitcnt vmcnt(19)
    buffer_load_dwordx4 a[84:87], v2, s[12:15], s101 offen offset:256 nt
    ds_read_b128 v[28:31], v15 offset:256
    ds_read_b64_tr_b16 v[240:241], v7 offset:33792
    ds_read_b64_tr_b16 v[242:243], v7 offset:35904
    ds_read_b64_tr_b16 v[244:245], v8 offset:33792
    ds_read_b64_tr_b16 v[246:247], v8 offset:35904
    ds_read_b64_tr_b16 v[248:249], v9 offset:33792
    ds_read_b64_tr_b16 v[250:251], v9 offset:35904
    ds_read_b64_tr_b16 v[252:253], v10 offset:33792
    ds_read_b64_tr_b16 v[254:255], v10 offset:35904
    s_waitcnt lgkmcnt(6)
    v_mfma_f32_16x16x32_bf16 v[176:179], v[28:31], v[240:243], v[176:179]
    s_waitcnt lgkmcnt(4)
    v_mfma_f32_16x16x32_bf16 v[180:183], v[28:31], v[244:247], v[180:183]
    s_waitcnt lgkmcnt(2)
    v_mfma_f32_16x16x32_bf16 v[184:187], v[28:31], v[248:251], v[184:187]
    s_waitcnt lgkmcnt(0)
    v_mfma_f32_16x16x32_bf16 v[188:191], v[28:31], v[252:255], v[188:191]
    s_waitcnt vmcnt(18)
    buffer_load_dwordx4 a[88:91], v2, s[12:15], s101 offen offset:2048 nt
    s_add_u32 m0, s61, 33792
    s_add_u32 s60, s62, 1835008
    buffer_load_dwordx4 v4, s[20:23], s60 offen lds
    s_waitcnt vmcnt(19)
    buffer_load_dwordx4 a[92:95], v2, s[12:15], s101 offen offset:2304 nt
    s_add_u32 m0, s61, 34848
    s_add_u32 s60, s62, 1966080
    buffer_load_dwordx4 v4, s[20:23], s60 offen lds
    s_waitcnt vmcnt(19)
    s_add_u32 s101, s7, 229376
    buffer_load_dwordx4 a[96:99], v2, s[12:15], s101 offen offset:0 nt
    s_waitcnt vmcnt(19)
    buffer_load_dwordx4 a[100:103], v2, s[12:15], s101 offen offset:256 nt
    s_add_u32 m0, s61, 35904
    s_add_u32 s60, s62, 1867776
    buffer_load_dwordx4 v4, s[20:23], s60 offen lds
    s_waitcnt vmcnt(19)
    buffer_load_dwordx4 a[104:107], v2, s[12:15], s101 offen offset:2048 nt
    s_waitcnt vmcnt(18)
    buffer_load_dwordx4 a[108:111], v2, s[12:15], s101 offen offset:2304 nt
    s_add_u32 m0, s61, 36960
    s_add_u32 s60, s62, 1998848
    buffer_load_dwordx4 v4, s[20:23], s60 offen lds
    ds_read_b128 v[28:31], v15 offset:320
    ds_read_b64_tr_b16 v[240:241], v7 offset:25344
    ds_read_b64_tr_b16 v[242:243], v7 offset:27456
    ds_read_b64_tr_b16 v[244:245], v8 offset:25344
    ds_read_b64_tr_b16 v[246:247], v8 offset:27456
    ds_read_b64_tr_b16 v[248:249], v9 offset:25344
    ds_read_b64_tr_b16 v[250:251], v9 offset:27456
    ds_read_b64_tr_b16 v[252:253], v10 offset:25344
    ds_read_b64_tr_b16 v[254:255], v10 offset:27456
    s_waitcnt lgkmcnt(6)
    v_mfma_f32_16x16x32_bf16 v[176:179], v[28:31], v[240:243], v[176:179]
    s_waitcnt lgkmcnt(4)
    v_mfma_f32_16x16x32_bf16 v[180:183], v[28:31], v[244:247], v[180:183]
    s_waitcnt lgkmcnt(2)
    v_mfma_f32_16x16x32_bf16 v[184:187], v[28:31], v[248:251], v[184:187]
    s_waitcnt lgkmcnt(0)
    v_mfma_f32_16x16x32_bf16 v[188:191], v[28:31], v[252:255], v[188:191]
    s_waitcnt vmcnt(19)
    s_add_u32 s101, s7, 245760
    buffer_load_dwordx4 a[112:115], v2, s[12:15], s101 offen offset:0 nt
    s_add_u32 m0, s61, 25344
    s_add_u32 s60, s62, 2097152
    buffer_load_dwordx4 v4, s[20:23], s60 offen lds
    s_barrier
    s_cmp_lg_u32 s3, 0
    s_cbranch_scc1 L_at
    v_mov_b32 v20, 1
    s_mov_b64 exec, 1
    buffer_atomic_add v20, off, s[56:59], 0 sc1
    s_mov_b64 exec, -1
L_at:
    s_waitcnt vmcnt(19)
    buffer_load_dwordx4 a[116:119], v2, s[12:15], s101 offen offset:256 nt
    s_waitcnt vmcnt(18)
    buffer_load_dwordx4 a[120:123], v2, s[12:15], s101 offen offset:2048 nt
    s_add_u32 m0, s61, 26400
    s_add_u32 s60, s62, 2228224
    buffer_load_dwordx4 v4, s[20:23], s60 offen lds
    s_waitcnt vmcnt(19)
    buffer_load_dwordx4 a[124:127], v2, s[12:15], s101 offen offset:2304 nt
    s_add_u32 m0, s61, 27456
    s_add_u32 s60, s62, 2129920
    buffer_load_dwordx4 v4, s[20:23], s60 offen lds
    s_waitcnt vmcnt(19)
    s_add_u32 s101, s7, 262144
    buffer_load_dwordx4 a[128:131], v2, s[12:15], s101 offen offset:0 nt
    s_waitcnt vmcnt(18)
    buffer_load_dwordx4 a[132:135], v2, s[12:15], s101 offen offset:256 nt
    s_add_u32 m0, s61, 28512
    s_add_u32 s60, s62, 2260992
    buffer_load_dwordx4 v4, s[20:23], s60 offen lds
    ds_read_b128 v[28:31], v15 offset:384
    ds_read_b64_tr_b16 v[240:241], v7 offset:29568
    ds_read_b64_tr_b16 v[242:243], v7 offset:31680
    ds_read_b64_tr_b16 v[244:245], v8 offset:29568
    ds_read_b64_tr_b16 v[246:247], v8 offset:31680
    ds_read_b64_tr_b16 v[248:249], v9 offset:29568
    ds_read_b64_tr_b16 v[250:251], v9 offset:31680
    ds_read_b64_tr_b16 v[252:253], v10 offset:29568
    ds_read_b64_tr_b16 v[254:255], v10 offset:31680
    s_waitcnt lgkmcnt(6)
    v_mfma_f32_16x16x32_bf16 v[176:179], v[28:31], v[240:243], v[176:179]
    s_waitcnt lgkmcnt(4)
    v_mfma_f32_16x16x32_bf16 v[180:183], v[28:31], v[244:247], v[180:183]
    s_waitcnt lgkmcnt(2)
    v_mfma_f32_16x16x32_bf16 v[184:187], v[28:31], v[248:251], v[184:187]
    s_waitcnt lgkmcnt(0)
    v_mfma_f32_16x16x32_bf16 v[188:191], v[28:31], v[252:255], v[188:191]
    s_waitcnt vmcnt(19)
    buffer_load_dwordx4 a[136:139], v2, s[12:15], s101 offen offset:2048 nt
    s_add_u32 m0, s61, 29568
    s_add_u32 s60, s62, 2359296
    buffer_load_dwordx4 v4, s[20:23], s60 offen lds
    s_waitcnt vmcnt(19)
    buffer_load_dwordx4 a[140:143], v2, s[12:15], s101 offen offset:2304 nt
    s_waitcnt vmcnt(18)
    s_add_u32 s101, s7, 278528
    buffer_load_dwordx4 a[144:147], v2, s[12:15], s101 offen offset:0 nt
    s_add_u32 m0, s61, 30624
    s_add_u32 s60, s62, 2490368
    buffer_load_dwordx4 v4, s[20:23], s60 offen lds
    s_waitcnt vmcnt(19)
    buffer_load_dwordx4 a[148:151], v2, s[12:15], s101 offen offset:256 nt
    s_add_u32 m0, s61, 31680
    s_add_u32 s60, s62, 2392064
    buffer_load_dwordx4 v4, s[20:23], s60 offen lds
    s_waitcnt vmcnt(19)
    buffer_load_dwordx4 a[152:155], v2, s[12:15], s101 offen offset:2048 nt
    s_waitcnt vmcnt(19)
    buffer_load_dwordx4 a[156:159], v2, s[12:15], s101 offen offset:2304 nt
    s_add_u32 m0, s61, 32736
    s_add_u32 s60, s62, 2523136
    buffer_load_dwordx4 v4, s[20:23], s60 offen lds
    s_waitcnt vmcnt(19)
    s_add_u32 s101, s7, 294912
    buffer_load_dwordx4 a[160:163], v2, s[12:15], s101 offen offset:0 nt
    ds_read_b128 v[28:31], v15 offset:448
    ds_read_b64_tr_b16 v[240:241], v7 offset:33792
    ds_read_b64_tr_b16 v[242:243], v7 offset:35904
    ds_read_b64_tr_b16 v[244:245], v8 offset:33792
    ds_read_b64_tr_b16 v[246:247], v8 offset:35904
    ds_read_b64_tr_b16 v[248:249], v9 offset:33792
    ds_read_b64_tr_b16 v[250:251], v9 offset:35904
    ds_read_b64_tr_b16 v[252:253], v10 offset:33792
    ds_read_b64_tr_b16 v[254:255], v10 offset:35904
    s_waitcnt lgkmcnt(6)
    v_mfma_f32_16x16x32_bf16 v[176:179], v[28:31], v[240:243], v[176:179]
    s_waitcnt lgkmcnt(4)
    v_mfma_f32_16x16x32_bf16 v[180:183], v[28:31], v[244:247], v[180:183]
    s_waitcnt lgkmcnt(2)
    v_mfma_f32_16x16x32_bf16 v[184:187], v[28:31], v[248:251], v[184:187]
    s_waitcnt lgkmcnt(0)
    v_mfma_f32_16x16x32_bf16 v[188:191], v[28:31], v[252:255], v[188:191]
    s_waitcnt vmcnt(18)
    buffer_load_dwordx4 a[164:167], v2, s[12:15], s101 offen offset:256 nt
    s_add_u32 m0, s61, 33792
    s_add_u32 s60, s62, 2621440
    buffer_load_dwordx4 v4, s[20:23], s60 offen lds
    s_waitcnt vmcnt(19)
    buffer_load_dwordx4 a[168:171], v2, s[12:15], s101 offen offset:2048 nt
    s_add_u32 m0, s61, 34848
    s_add_u32 s60, s62, 2752512
    buffer_load_dwordx4 v4, s[20:23], s60 offen lds
    s_waitcnt vmcnt(19)
    buffer_load_dwordx4 a[172:175], v2, s[12:15], s101 offen offset:2304 nt
    s_waitcnt vmcnt(18)
    s_add_u32 s101, s7, 311296
    buffer_load_dwordx4 a[176:179], v2, s[12:15], s101 offen offset:0 nt
    s_add_u32 m0, s61, 35904
    s_add_u32 s60, s62, 2654208
    buffer_load_dwordx4 v4, s[20:23], s60 offen lds
    s_waitcnt vmcnt(19)
    buffer_load_dwordx4 a[180:183], v2, s[12:15], s101 offen offset:256 nt
    s_add_u32 m0, s61, 36960
    s_add_u32 s60, s62, 2785280
    buffer_load_dwordx4 v4, s[20:23], s60 offen lds
    s_waitcnt vmcnt(19)
    buffer_load_dwordx4 a[184:187], v2, s[12:15], s101 offen offset:2048 nt
    ds_read_b128 v[28:31], v15 offset:512
    ds_read_b64_tr_b16 v[240:241], v7 offset:25344
    ds_read_b64_tr_b16 v[242:243], v7 offset:27456
    ds_read_b64_tr_b16 v[244:245], v8 offset:25344
    ds_read_b64_tr_b16 v[246:247], v8 offset:27456
    ds_read_b64_tr_b16 v[248:249], v9 offset:25344
    ds_read_b64_tr_b16 v[250:251], v9 offset:27456
    ds_read_b64_tr_b16 v[252:253], v10 offset:25344
    ds_read_b64_tr_b16 v[254:255], v10 offset:27456
    s_waitcnt lgkmcnt(6)
    v_mfma_f32_16x16x32_bf16 v[176:179], v[28:31], v[240:243], v[176:179]
    s_waitcnt lgkmcnt(4)
    v_mfma_f32_16x16x32_bf16 v[180:183], v[28:31], v[244:247], v[180:183]
    s_waitcnt lgkmcnt(2)
    v_mfma_f32_16x16x32_bf16 v[184:187], v[28:31], v[248:251], v[184:187]
    s_waitcnt lgkmcnt(0)
    v_mfma_f32_16x16x32_bf16 v[188:191], v[28:31], v[252:255], v[188:191]
    s_waitcnt vmcnt(18)
    buffer_load_dwordx4 a[188:191], v2, s[12:15], s101 offen offset:2304 nt
    s_add_u32 m0, s61, 25344
    s_add_u32 s60, s62, 2883584
    buffer_load_dwordx4 v4, s[20:23], s60 offen lds
    s_waitcnt vmcnt(19)
    s_add_u32 s101, s7, 327680
    buffer_load_dwordx4 a[192:195], v2, s[12:15], s101 offen offset:0 nt
    s_add_u32 m0, s61, 26400
    s_add_u32 s60, s62, 3014656
    buffer_load_dwordx4 v4, s[20:23], s60 offen lds
    s_waitcnt vmcnt(19)
    buffer_load_dwordx4 a[196:199], v2, s[12:15], s101 offen offset:256 nt
    s_waitcnt vmcnt(18)
    buffer_load_dwordx4 a[200:203], v2, s[12:15], s101 offen offset:2048 nt
    s_add_u32 m0, s61, 27456
    s_add_u32 s60, s62, 2916352
    buffer_load_dwordx4 v4, s[20:23], s60 offen lds
    buffer_load_dword v19, off, s[40:43], 0 sc1
    s_waitcnt vmcnt(20)
    buffer_load_dwordx4 a[204:207], v2, s[12:15], s101 offen offset:2304 nt
    s_waitcnt vmcnt(19)
    s_add_u32 s101, s7, 344064
    buffer_load_dwordx4 a[208:211], v2, s[12:15], s101 offen offset:0 nt
    s_add_u32 m0, s61, 28512
    s_add_u32 s60, s62, 3047424
    buffer_load_dwordx4 v4, s[20:23], s60 offen lds
    ds_read_b128 v[28:31], v15 offset:576
    ds_read_b64_tr_b16 v[240:241], v7 offset:29568
    ds_read_b64_tr_b16 v[242:243], v7 offset:31680
    ds_read_b64_tr_b16 v[244:245], v8 offset:29568
    ds_read_b64_tr_b16 v[246:247], v8 offset:31680
    ds_read_b64_tr_b16 v[248:249], v9 offset:29568
    ds_read_b64_tr_b16 v[250:251], v9 offset:31680
    ds_read_b64_tr_b16 v[252:253], v10 offset:29568
    ds_read_b64_tr_b16 v[254:255], v10 offset:31680
    s_waitcnt lgkmcnt(6)
    v_mfma_f32_16x16x32_bf16 v[176:179], v[28:31], v[240:243], v[176:179]
    s_waitcnt lgkmcnt(4)
    v_mfma_f32_16x16x32_bf16 v[180:183], v[28:31], v[244:247], v[180:183]
    s_waitcnt lgkmcnt(2)
    v_mfma_f32_16x16x32_bf16 v[184:187], v[28:31], v[248:251], v[184:187]
    s_waitcnt lgkmcnt(0)
    v_mfma_f32_16x16x32_bf16 v[188:191], v[28:31], v[252:255], v[188:191]
    s_waitcnt vmcnt(20)
    buffer_load_dwordx4 a[212:215], v2, s[12:15], s101 offen offset:256 nt
    s_add_u32 m0, s61, 29568
    s_add_u32 s60, s62, 3145728
    buffer_load_dwordx4 v4, s[20:23], s60 offen lds
    s_waitcnt vmcnt(20)
    buffer_load_dwordx4 a[216:219], v2, s[12:15], s101 offen offset:2048 nt
    s_waitcnt vmcnt(19)
    buffer_load_dwordx4 a[220:223], v2, s[12:15], s101 offen offset:2304 nt
    s_add_u32 m0, s61, 30624
    s_add_u32 s60, s62, 3276800
    buffer_load_dwordx4 v4, s[20:23], s60 offen lds
    s_waitcnt vmcnt(20)
    s_add_u32 s101, s7, 360448
    buffer_load_dwordx4 a[224:227], v2, s[12:15], s101 offen offset:0 nt
    s_add_u32 m0, s61, 31680
    s_add_u32 s60, s62, 3178496
    buffer_load_dwordx4 v4, s[20:23], s60 offen lds
    s_waitcnt vmcnt(20)
    buffer_load_dwordx4 a[228:231], v2, s[12:15], s101 offen offset:256 nt
    s_waitcnt vmcnt(19)
    buffer_load_dwordx4 a[232:235], v2, s[12:15], s101 offen offset:2048 nt
    s_add_u32 m0, s61, 32736
    s_add_u32 s60, s62, 3309568
    buffer_load_dwordx4 v4, s[20:23], s60 offen lds
    ds_read_b128 v[28:31], v15 offset:640
    ds_read_b64_tr_b16 v[240:241], v7 offset:33792
    ds_read_b64_tr_b16 v[242:243], v7 offset:35904
    ds_read_b64_tr_b16 v[244:245], v8 offset:33792
    ds_read_b64_tr_b16 v[246:247], v8 offset:35904
    ds_read_b64_tr_b16 v[248:249], v9 offset:33792
    ds_read_b64_tr_b16 v[250:251], v9 offset:35904
    ds_read_b64_tr_b16 v[252:253], v10 offset:33792
    ds_read_b64_tr_b16 v[254:255], v10 offset:35904
    s_waitcnt lgkmcnt(6)
    v_mfma_f32_16x16x32_bf16 v[176:179], v[28:31], v[240:243], v[176:179]
    s_waitcnt lgkmcnt(4)
    v_mfma_f32_16x16x32_bf16 v[180:183], v[28:31], v[244:247], v[180:183]
    s_waitcnt lgkmcnt(2)
    v_mfma_f32_16x16x32_bf16 v[184:187], v[28:31], v[248:251], v[184:187]
    s_waitcnt lgkmcnt(0)
    v_mfma_f32_16x16x32_bf16 v[188:191], v[28:31], v[252:255], v[188:191]
    s_waitcnt vmcnt(20)
    buffer_load_dwordx4 a[236:239], v2, s[12:15], s101 offen offset:2304 nt
    s_add_u32 m0, s61, 33792
    s_add_u32 s60, s62, 3407872
    buffer_load_dwordx4 v4, s[20:23], s60 offen lds
    s_waitcnt vmcnt(20)
    s_add_u32 s101, s7, 376832
    buffer_load_dwordx4 a[240:243], v2, s[12:15], s101 offen offset:0 nt
    s_waitcnt vmcnt(19)
    buffer_load_dwordx4 a[244:247], v2, s[12:15], s101 offen offset:256 nt
    s_add_u32 m0, s61, 34848
    s_add_u32 s60, s62, 3538944
    buffer_load_dwordx4 v4, s[20:23], s60 offen lds
    s_waitcnt vmcnt(20)
    buffer_load_dwordx4 a[248:251], v2, s[12:15], s101 offen offset:2048 nt
    s_add_u32 m0, s61, 35904
    s_add_u32 s60, s62, 3440640
    buffer_load_dwordx4 v4, s[20:23], s60 offen lds
    s_waitcnt vmcnt(19)
    buffer_load_dwordx4 a[252:255], v2, s[12:15], s101 offen offset:2304 nt
    s_waitcnt vmcnt(19)
    s_add_u32 m0, s61, 0
    s_add_u32 s60, s7, 0
    buffer_load_dwordx4 v3, s[16:19], s60 offen nt lds
    s_add_u32 m0, s61, 36960
    s_add_u32 s60, s62, 3571712
    buffer_load_dwordx4 v4, s[20:23], s60 offen lds
    s_waitcnt vmcnt(19)
    s_add_u32 m0, s61, 1056
    s_add_u32 s60, s7, 1024
    buffer_load_dwordx4 v3, s[16:19], s60 offen nt lds
    ds_read_b128 v[28:31], v15 offset:704
    ds_read_b64_tr_b16 v[240:241], v7 offset:25344
    ds_read_b64_tr_b16 v[242:243], v7 offset:27456
    ds_read_b64_tr_b16 v[244:245], v8 offset:25344
    ds_read_b64_tr_b16 v[246:247], v8 offset:27456
    ds_read_b64_tr_b16 v[248:249], v9 offset:25344
    ds_read_b64_tr_b16 v[250:251], v9 offset:27456
    ds_read_b64_tr_b16 v[252:253], v10 offset:25344
    ds_read_b64_tr_b16 v[254:255], v10 offset:27456
    s_waitcnt lgkmcnt(6)
    v_mfma_f32_16x16x32_bf16 v[176:179], v[28:31], v[240:243], v[176:179]
    s_waitcnt lgkmcnt(4)
    v_mfma_f32_16x16x32_bf16 v[180:183], v[28:31], v[244:247], v[180:183]
    s_waitcnt lgkmcnt(2)
    v_mfma_f32_16x16x32_bf16 v[184:187], v[28:31], v[248:251], v[184:187]
    s_waitcnt lgkmcnt(0)
    v_mfma_f32_16x16x32_bf16 v[188:191], v[28:31], v[252:255], v[188:191]
    s_waitcnt vmcnt(18)
    s_add_u32 m0, s61, 2112
    s_add_u32 s60, s7, 2048
    buffer_load_dwordx4 v3, s[16:19], s60 offen nt lds
    s_mov_b32 s93, 262144
    s_cmp_lg_u32 s3, 0
    s_cbranch_scc1 L_cnt_ok
L_cnt:
    v_readfirstlane_b32 s90, v19
    s_nop 0
    s_cmp_ge_u32 s90, 84
    s_cbranch_scc1 L_cnt_ok
    s_sub_u32 s93, s93, 1
    s_cbranch_scc1 L_cnt_ok
    buffer_load_dword v19, off, s[40:43], 0 sc1
    s_waitcnt vmcnt(0)
    s_branch L_cnt
L_cnt_ok:
    s_barrier
    ds_read_b128 v[224:227], v16 offset:4416
    ds_read_b128 v[228:231], v16 offset:5440
    ds_read_b128 v[232:235], v16 offset:6464
    ds_read_b128 v[236:239], v16 offset:7488
    v_lshrrev_b32 v22, 5, v1
    v_lshlrev_b32 v22, 12, v22
    v_and_b32 v23, 0x1ff, v16
    v_add_u32 v22, v22, v23
    s_waitcnt lgkmcnt(0)
    v_pk_add_f32 v[224:225], v[224:225], v[228:229]
    v_pk_add_f32 v[232:233], v[232:233], v[236:237]
    v_pk_add_f32 v[226:227], v[226:227], v[230:231]
    v_pk_add_f32 v[234:235], v[234:235], v[238:239]
    v_pk_add_f32 v[224:225], v[224:225], v[232:233]
    v_pk_add_f32 v[226:227], v[226:227], v[234:235]
    buffer_store_dwordx4 v[224:227], v22, s[44:47], s100 offen sc1
    s_waitcnt vmcnt(19)
    s_add_u32 m0, s61, 3168
    s_add_u32 s60, s7, 3072
    buffer_load_dwordx4 v3, s[16:19], s60 offen nt lds
    s_waitcnt vmcnt(18)
    s_add_u32 m0, s61, 4224
    s_add_u32 s60, s7, 16384
    buffer_load_dwordx4 v3, s[16:19], s60 offen nt lds
    s_add_u32 m0, s61, 25344
    s_add_u32 s60, s63, 182784
    buffer_load_dwordx4 v6, s[24:27], s60 offen lds
    s_waitcnt vmcnt(18)
    s_add_u32 m0, s61, 5280
    s_add_u32 s60, s7, 17408
    buffer_load_dwordx4 v3, s[16:19], s60 offen nt lds
    s_waitcnt vmcnt(18)
    s_add_u32 m0, s61, 6336
    s_add_u32 s60, s7, 18432
    buffer_load_dwordx4 v3, s[16:19], s60 offen nt lds
    s_add_u32 m0, s61, 26400
    s_add_u32 s60, s63, 197120
    buffer_load_dwordx4 v6, s[24:27], s60 offen lds
    s_waitcnt vmcnt(18)
    s_add_u32 m0, s61, 7392
    s_add_u32 s60, s7, 19456
    buffer_load_dwordx4 v3, s[16:19], s60 offen nt lds
    ds_read_b128 v[28:31], v15 offset:768
    ds_read_b64_tr_b16 v[240:241], v7 offset:29568
    ds_read_b64_tr_b16 v[242:243], v7 offset:31680
    ds_read_b64_tr_b16 v[244:245], v8 offset:29568
    ds_read_b64_tr_b16 v[246:247], v8 offset:31680
    ds_read_b64_tr_b16 v[248:249], v9 offset:29568
    ds_read_b64_tr_b16 v[250:251], v9 offset:31680
    ds_read_b64_tr_b16 v[252:253], v10 offset:29568
    ds_read_b64_tr_b16 v[254:255], v10 offset:31680
    s_waitcnt lgkmcnt(6)
    v_mfma_f32_16x16x32_bf16 v[176:179], v[28:31], v[240:243], v[176:179]
    s_waitcnt lgkmcnt(4)
    v_mfma_f32_16x16x32_bf16 v[180:183], v[28:31], v[244:247], v[180:183]
    s_waitcnt lgkmcnt(2)
    v_mfma_f32_16x16x32_bf16 v[184:187], v[28:31], v[248:251], v[184:187]
    s_waitcnt lgkmcnt(0)
    v_mfma_f32_16x16x32_bf16 v[188:191], v[28:31], v[252:255], v[188:191]
    s_waitcnt vmcnt(17)
    s_add_u32 m0, s61, 8448
    s_add_u32 s60, s7, 32768
    buffer_load_dwordx4 v3, s[16:19], s60 offen nt lds
    s_add_u32 m0, s61, 27456
    s_add_u32 s60, s63, 211456
    buffer_load_dwordx4 v6, s[24:27], s60 offen lds
    s_waitcnt vmcnt(18)
    s_add_u32 m0, s61, 9504
    s_add_u32 s60, s7, 33792
    buffer_load_dwordx4 v3, s[16:19], s60 offen nt lds
    s_waitcnt vmcnt(17)
    s_add_u32 m0, s61, 10560
    s_add_u32 s60, s7, 34816
    buffer_load_dwordx4 v3, s[16:19], s60 offen nt lds
    s_add_u32 m0, s61, 28512
    s_add_u32 s60, s63, 225792
    buffer_load_dwordx4 v6, s[24:27], s60 offen lds
    s_waitcnt vmcnt(17)
    s_add_u32 m0, s61, 11616
    s_add_u32 s60, s7, 35840
    buffer_load_dwordx4 v3, s[16:19], s60 offen nt lds
    s_waitcnt vmcnt(17)
    s_add_u32 m0, s61, 12672
    s_add_u32 s60, s7, 49152
    buffer_load_dwordx4 v3, s[16:19], s60 offen nt lds
    s_add_u32 m0, s61, 29568
    s_add_u32 s60, s63, 125440
    buffer_load_dwordx4 v6, s[24:27], s60 offen lds
    s_waitcnt vmcnt(17)
    s_add_u32 m0, s61, 13728
    s_add_u32 s60, s7, 50176
    buffer_load_dwordx4 v3, s[16:19], s60 offen nt lds
    ds_read_b128 v[28:31], v15 offset:832
    ds_read_b64_tr_b16 v[240:241], v7 offset:33792
    ds_read_b64_tr_b16 v[242:243], v7 offset:35904
    ds_read_b64_tr_b16 v[244:245], v8 offset:33792
    ds_read_b64_tr_b16 v[246:247], v8 offset:35904
    ds_read_b64_tr_b16 v[248:249], v9 offset:33792
    ds_read_b64_tr_b16 v[250:251], v9 offset:35904
    ds_read_b64_tr_b16 v[252:253], v10 offset:33792
    ds_read_b64_tr_b16 v[254:255], v10 offset:35904
    s_waitcnt lgkmcnt(6)
    v_mfma_f32_16x16x32_bf16 v[176:179], v[28:31], v[240:243], v[176:179]
    s_waitcnt lgkmcnt(4)
    v_mfma_f32_16x16x32_bf16 v[180:183], v[28:31], v[244:247], v[180:183]
    s_waitcnt lgkmcnt(2)
    v_mfma_f32_16x16x32_bf16 v[184:187], v[28:31], v[248:251], v[184:187]
    s_waitcnt lgkmcnt(0)
    v_mfma_f32_16x16x32_bf16 v[188:191], v[28:31], v[252:255], v[188:191]
    s_lshl_b32 s90, s3, 7
    v_lshlrev_b32 v24, 1, v1
    v_add_u32 v24, s90, v24
    s_nop 0
    v_cvt_pk_bf16_f32 v20, v176, v180
    s_nop 2
    v_cvt_pk_bf16_f32 v21, v184, v188
    s_mov_b64 exec, 0xffff
    ds_write_b16 v24, v20 offset:3840
    ds_write_b16_d16_hi v24, v20 offset:3872
    ds_write_b16 v24, v21 offset:3904
    ds_write_b16_d16_hi v24, v21 offset:3936
    s_mov_b64 exec, -1
    v_and_b32 v21, 0x1ff, v2
    s_waitcnt lgkmcnt(0)
    s_barrier
    ds_read_b128 v[160:163], v21 offset:3840
    ds_read_b128 v[164:167], v21 offset:4096
    s_waitcnt lgkmcnt(0)
    v_mfma_f32_16x16x32_bf16 v[224:227], a[0:3], v[160:163], 0
    v_mfma_f32_16x16x32_bf16 v[228:231], a[8:11], v[160:163], 0
    v_mfma_f32_16x16x32_bf16 v[232:235], a[16:19], v[160:163], 0
    v_mfma_f32_16x16x32_bf16 v[236:239], a[24:27], v[160:163], 0
    v_mfma_f32_16x16x32_bf16 v[224:227], a[4:7], v[164:167], v[224:227]
    v_mfma_f32_16x16x32_bf16 v[228:231], a[12:15], v[164:167], v[228:231]
    v_mfma_f32_16x16x32_bf16 v[232:235], a[20:23], v[164:167], v[232:235]
    v_mfma_f32_16x16x32_bf16 v[236:239], a[28:31], v[164:167], v[236:239]
    s_nop 4
    v_mov_b32_dpp v168, v224 quad_perm:[0,0,0,0] row_mask:0xf bank_mask:0xf
    v_mov_b32_dpp v169, v228 quad_perm:[0,0,0,0] row_mask:0xf bank_mask:0xf
    v_mov_b32_dpp v170, v232 quad_perm:[0,0,0,0] row_mask:0xf bank_mask:0xf
    v_mov_b32_dpp v171, v236 quad_perm:[0,0,0,0] row_mask:0xf bank_mask:0xf
    v_add_f32_dpp v168, v225, v168 quad_perm:[1,1,1,1] row_mask:0xf bank_mask:0xf
    v_add_f32_dpp v169, v229, v169 quad_perm:[1,1,1,1] row_mask:0xf bank_mask:0xf
    v_add_f32_dpp v170, v233, v170 quad_perm:[1,1,1,1] row_mask:0xf bank_mask:0xf
    v_add_f32_dpp v171, v237, v171 quad_perm:[1,1,1,1] row_mask:0xf bank_mask:0xf
    v_add_f32_dpp v168, v226, v168 quad_perm:[2,2,2,2] row_mask:0xf bank_mask:0xf
    v_add_f32_dpp v169, v230, v169 quad_perm:[2,2,2,2] row_mask:0xf bank_mask:0xf
    v_add_f32_dpp v170, v234, v170 quad_perm:[2,2,2,2] row_mask:0xf bank_mask:0xf
    v_add_f32_dpp v171, v238, v171 quad_perm:[2,2,2,2] row_mask:0xf bank_mask:0xf
    v_add_f32_dpp v168, v227, v168 quad_perm:[3,3,3,3] row_mask:0xf bank_mask:0xf
    v_add_f32_dpp v169, v231, v169 quad_perm:[3,3,3,3] row_mask:0xf bank_mask:0xf
    v_add_f32_dpp v170, v235, v170 quad_perm:[3,3,3,3] row_mask:0xf bank_mask:0xf
    v_add_f32_dpp v171, v239, v171 quad_perm:[3,3,3,3] row_mask:0xf bank_mask:0xf
    v_max3_f32 v18, v168, v169, v18
    v_max3_f32 v18, v170, v171, v18
    v_cvt_pk_bf16_f32 v200, v168, v169
    v_cvt_pk_bf16_f32 v201, v170, v171
    s_waitcnt vmcnt(17)
    s_add_u32 m0, s61, 14784
    s_add_u32 s60, s7, 51200
    buffer_load_dwordx4 v3, s[16:19], s60 offen nt lds
    s_add_u32 m0, s61, 30624
    s_add_u32 s60, s63, 139776
    buffer_load_dwordx4 v6, s[24:27], s60 offen lds
    v_mfma_f32_16x16x32_bf16 v[224:227], a[32:35], v[160:163], 0
    v_mfma_f32_16x16x32_bf16 v[228:231], a[40:43], v[160:163], 0
    v_mfma_f32_16x16x32_bf16 v[232:235], a[48:51], v[160:163], 0
    v_mfma_f32_16x16x32_bf16 v[236:239], a[56:59], v[160:163], 0
    v_mfma_f32_16x16x32_bf16 v[224:227], a[36:39], v[164:167], v[224:227]
    v_mfma_f32_16x16x32_bf16 v[228:231], a[44:47], v[164:167], v[228:231]
    v_mfma_f32_16x16x32_bf16 v[232:235], a[52:55], v[164:167], v[232:235]
    v_mfma_f32_16x16x32_bf16 v[236:239], a[60:63], v[164:167], v[236:239]
    s_nop 4
    v_mov_b32_dpp v168, v224 quad_perm:[0,0,0,0] row_mask:0xf bank_mask:0xf
    v_mov_b32_dpp v169, v228 quad_perm:[0,0,0,0] row_mask:0xf bank_mask:0xf
    v_mov_b32_dpp v170, v232 quad_perm:[0,0,0,0] row_mask:0xf bank_mask:0xf
    v_mov_b32_dpp v171, v236 quad_perm:[0,0,0,0] row_mask:0xf bank_mask:0xf
    v_add_f32_dpp v168, v225, v168 quad_perm:[1,1,1,1] row_mask:0xf bank_mask:0xf
    v_add_f32_dpp v169, v229, v169 quad_perm:[1,1,1,1] row_mask:0xf bank_mask:0xf
    v_add_f32_dpp v170, v233, v170 quad_perm:[1,1,1,1] row_mask:0xf bank_mask:0xf
    v_add_f32_dpp v171, v237, v171 quad_perm:[1,1,1,1] row_mask:0xf bank_mask:0xf
    v_add_f32_dpp v168, v226, v168 quad_perm:[2,2,2,2] row_mask:0xf bank_mask:0xf
    v_add_f32_dpp v169, v230, v169 quad_perm:[2,2,2,2] row_mask:0xf bank_mask:0xf
    v_add_f32_dpp v170, v234, v170 quad_perm:[2,2,2,2] row_mask:0xf bank_mask:0xf
    v_add_f32_dpp v171, v238, v171 quad_perm:[2,2,2,2] row_mask:0xf bank_mask:0xf
    v_add_f32_dpp v168, v227, v168 quad_perm:[3,3,3,3] row_mask:0xf bank_mask:0xf
    v_add_f32_dpp v169, v231, v169 quad_perm:[3,3,3,3] row_mask:0xf bank_mask:0xf
    v_add_f32_dpp v170, v235, v170 quad_perm:[3,3,3,3] row_mask:0xf bank_mask:0xf
    v_add_f32_dpp v171, v239, v171 quad_perm:[3,3,3,3] row_mask:0xf bank_mask:0xf
    v_max3_f32 v18, v168, v169, v18
    v_max3_f32 v18, v170, v171, v18
    v_cvt_pk_bf16_f32 v202, v168, v169
    v_cvt_pk_bf16_f32 v203, v170, v171
    s_waitcnt vmcnt(17)
    s_add_u32 m0, s61, 15840
    s_add_u32 s60, s7, 52224
    buffer_load_dwordx4 v3, s[16:19], s60 offen nt lds
    s_add_u32 m0, s61, 31680
    s_add_u32 s60, s63, 154112
    buffer_load_dwordx4 v6, s[24:27], s60 offen lds
    v_mfma_f32_16x16x32_bf16 v[224:227], a[64:67], v[160:163], 0
    v_mfma_f32_16x16x32_bf16 v[228:231], a[72:75], v[160:163], 0
    v_mfma_f32_16x16x32_bf16 v[232:235], a[80:83], v[160:163], 0
    v_mfma_f32_16x16x32_bf16 v[236:239], a[88:91], v[160:163], 0
    v_mfma_f32_16x16x32_bf16 v[224:227], a[68:71], v[164:167], v[224:227]
    v_mfma_f32_16x16x32_bf16 v[228:231], a[76:79], v[164:167], v[228:231]
    v_mfma_f32_16x16x32_bf16 v[232:235], a[84:87], v[164:167], v[232:235]
    v_mfma_f32_16x16x32_bf16 v[236:239], a[92:95], v[164:167], v[236:239]
    s_nop 4
    v_mov_b32_dpp v168, v224 quad_perm:[0,0,0,0] row_mask:0xf bank_mask:0xf
    v_mov_b32_dpp v169, v228 quad_perm:[0,0,0,0] row_mask:0xf bank_mask:0xf
    v_mov_b32_dpp v170, v232 quad_perm:[0,0,0,0] row_mask:0xf bank_mask:0xf
    v_mov_b32_dpp v171, v236 quad_perm:[0,0,0,0] row_mask:0xf bank_mask:0xf
    v_add_f32_dpp v168, v225, v168 quad_perm:[1,1,1,1] row_mask:0xf bank_mask:0xf
    v_add_f32_dpp v169, v229, v169 quad_perm:[1,1,1,1] row_mask:0xf bank_mask:0xf
    v_add_f32_dpp v170, v233, v170 quad_perm:[1,1,1,1] row_mask:0xf bank_mask:0xf
    v_add_f32_dpp v171, v237, v171 quad_perm:[1,1,1,1] row_mask:0xf bank_mask:0xf
    v_add_f32_dpp v168, v226, v168 quad_perm:[2,2,2,2] row_mask:0xf bank_mask:0xf
    v_add_f32_dpp v169, v230, v169 quad_perm:[2,2,2,2] row_mask:0xf bank_mask:0xf
    v_add_f32_dpp v170, v234, v170 quad_perm:[2,2,2,2] row_mask:0xf bank_mask:0xf
    v_add_f32_dpp v171, v238, v171 quad_perm:[2,2,2,2] row_mask:0xf bank_mask:0xf
    v_add_f32_dpp v168, v227, v168 quad_perm:[3,3,3,3] row_mask:0xf bank_mask:0xf
    v_add_f32_dpp v169, v231, v169 quad_perm:[3,3,3,3] row_mask:0xf bank_mask:0xf
    v_add_f32_dpp v170, v235, v170 quad_perm:[3,3,3,3] row_mask:0xf bank_mask:0xf
    v_add_f32_dpp v171, v239, v171 quad_perm:[3,3,3,3] row_mask:0xf bank_mask:0xf
    v_max3_f32 v18, v168, v169, v18
    v_max3_f32 v18, v170, v171, v18
    v_cvt_pk_bf16_f32 v204, v168, v169
    v_cvt_pk_bf16_f32 v205, v170, v171
    s_waitcnt vmcnt(18)
    s_add_u32 m0, s61, 16896
    s_add_u32 s60, s7, 65536
    buffer_load_dwordx4 v3, s[16:19], s60 offen nt lds
    v_mfma_f32_16x16x32_bf16 v[224:227], a[96:99], v[160:163], 0
    v_mfma_f32_16x16x32_bf16 v[228:231], a[104:107], v[160:163], 0
    v_mfma_f32_16x16x32_bf16 v[232:235], a[112:115], v[160:163], 0
    v_mfma_f32_16x16x32_bf16 v[236:239], a[120:123], v[160:163], 0
    v_mfma_f32_16x16x32_bf16 v[224:227], a[100:103], v[164:167], v[224:227]
    v_mfma_f32_16x16x32_bf16 v[228:231], a[108:111], v[164:167], v[228:231]
    v_mfma_f32_16x16x32_bf16 v[232:235], a[116:119], v[164:167], v[232:235]
    v_mfma_f32_16x16x32_bf16 v[236:239], a[124:127], v[164:167], v[236:239]
    s_nop 4
    v_mov_b32_dpp v168, v224 quad_perm:[0,0,0,0] row_mask:0xf bank_mask:0xf
    v_mov_b32_dpp v169, v228 quad_perm:[0,0,0,0] row_mask:0xf bank_mask:0xf
    v_mov_b32_dpp v170, v232 quad_perm:[0,0,0,0] row_mask:0xf bank_mask:0xf
    v_mov_b32_dpp v171, v236 quad_perm:[0,0,0,0] row_mask:0xf bank_mask:0xf
    v_add_f32_dpp v168, v225, v168 quad_perm:[1,1,1,1] row_mask:0xf bank_mask:0xf
    v_add_f32_dpp v169, v229, v169 quad_perm:[1,1,1,1] row_mask:0xf bank_mask:0xf
    v_add_f32_dpp v170, v233, v170 quad_perm:[1,1,1,1] row_mask:0xf bank_mask:0xf
    v_add_f32_dpp v171, v237, v171 quad_perm:[1,1,1,1] row_mask:0xf bank_mask:0xf
    v_add_f32_dpp v168, v226, v168 quad_perm:[2,2,2,2] row_mask:0xf bank_mask:0xf
    v_add_f32_dpp v169, v230, v169 quad_perm:[2,2,2,2] row_mask:0xf bank_mask:0xf
    v_add_f32_dpp v170, v234, v170 quad_perm:[2,2,2,2] row_mask:0xf bank_mask:0xf
    v_add_f32_dpp v171, v238, v171 quad_perm:[2,2,2,2] row_mask:0xf bank_mask:0xf
    v_add_f32_dpp v168, v227, v168 quad_perm:[3,3,3,3] row_mask:0xf bank_mask:0xf
    v_add_f32_dpp v169, v231, v169 quad_perm:[3,3,3,3] row_mask:0xf bank_mask:0xf
    v_add_f32_dpp v170, v235, v170 quad_perm:[3,3,3,3] row_mask:0xf bank_mask:0xf
    v_add_f32_dpp v171, v239, v171 quad_perm:[3,3,3,3] row_mask:0xf bank_mask:0xf
    v_max3_f32 v18, v168, v169, v18
    v_max3_f32 v18, v170, v171, v18
    v_cvt_pk_bf16_f32 v206, v168, v169
    v_cvt_pk_bf16_f32 v207, v170, v171
    s_waitcnt vmcnt(17)
    s_add_u32 m0, s61, 17952
    s_add_u32 s60, s7, 66560
    buffer_load_dwordx4 v3, s[16:19], s60 offen nt lds
    s_add_u32 m0, s61, 32736
    s_add_u32 s60, s63, 168448
    buffer_load_dwordx4 v6, s[24:27], s60 offen lds
    v_mfma_f32_16x16x32_bf16 v[224:227], a[128:131], v[160:163], 0
    v_mfma_f32_16x16x32_bf16 v[228:231], a[136:139], v[160:163], 0
    v_mfma_f32_16x16x32_bf16 v[232:235], a[144:147], v[160:163], 0
    v_mfma_f32_16x16x32_bf16 v[236:239], a[152:155], v[160:163], 0
    v_mfma_f32_16x16x32_bf16 v[224:227], a[132:135], v[164:167], v[224:227]
    v_mfma_f32_16x16x32_bf16 v[228:231], a[140:143], v[164:167], v[228:231]
    v_mfma_f32_16x16x32_bf16 v[232:235], a[148:151], v[164:167], v[232:235]
    v_mfma_f32_16x16x32_bf16 v[236:239], a[156:159], v[164:167], v[236:239]
    s_nop 4
    v_mov_b32_dpp v168, v224 quad_perm:[0,0,0,0] row_mask:0xf bank_mask:0xf
    v_mov_b32_dpp v169, v228 quad_perm:[0,0,0,0] row_mask:0xf bank_mask:0xf
    v_mov_b32_dpp v170, v232 quad_perm:[0,0,0,0] row_mask:0xf bank_mask:0xf
    v_mov_b32_dpp v171, v236 quad_perm:[0,0,0,0] row_mask:0xf bank_mask:0xf
    v_add_f32_dpp v168, v225, v168 quad_perm:[1,1,1,1] row_mask:0xf bank_mask:0xf
    v_add_f32_dpp v169, v229, v169 quad_perm:[1,1,1,1] row_mask:0xf bank_mask:0xf
    v_add_f32_dpp v170, v233, v170 quad_perm:[1,1,1,1] row_mask:0xf bank_mask:0xf
    v_add_f32_dpp v171, v237, v171 quad_perm:[1,1,1,1] row_mask:0xf bank_mask:0xf
    v_add_f32_dpp v168, v226, v168 quad_perm:[2,2,2,2] row_mask:0xf bank_mask:0xf
    v_add_f32_dpp v169, v230, v169 quad_perm:[2,2,2,2] row_mask:0xf bank_mask:0xf
    v_add_f32_dpp v170, v234, v170 quad_perm:[2,2,2,2] row_mask:0xf bank_mask:0xf
    v_add_f32_dpp v171, v238, v171 quad_perm:[2,2,2,2] row_mask:0xf bank_mask:0xf
    v_add_f32_dpp v168, v227, v168 quad_perm:[3,3,3,3] row_mask:0xf bank_mask:0xf
    v_add_f32_dpp v169, v231, v169 quad_perm:[3,3,3,3] row_mask:0xf bank_mask:0xf
    v_add_f32_dpp v170, v235, v170 quad_perm:[3,3,3,3] row_mask:0xf bank_mask:0xf
    v_add_f32_dpp v171, v239, v171 quad_perm:[3,3,3,3] row_mask:0xf bank_mask:0xf
    v_max3_f32 v18, v168, v169, v18
    v_max3_f32 v18, v170, v171, v18
    v_cvt_pk_bf16_f32 v208, v168, v169
    v_cvt_pk_bf16_f32 v209, v170, v171
    s_waitcnt vmcnt(18)
    s_add_u32 m0, s61, 19008
    s_add_u32 s60, s7, 67584
    buffer_load_dwordx4 v3, s[16:19], s60 offen nt lds
    v_mfma_f32_16x16x32_bf16 v[224:227], a[160:163], v[160:163], 0
    v_mfma_f32_16x16x32_bf16 v[228:231], a[168:171], v[160:163], 0
    v_mfma_f32_16x16x32_bf16 v[232:235], a[176:179], v[160:163], 0
    v_mfma_f32_16x16x32_bf16 v[236:239], a[184:187], v[160:163], 0
    v_mfma_f32_16x16x32_bf16 v[224:227], a[164:167], v[164:167], v[224:227]
    v_mfma_f32_16x16x32_bf16 v[228:231], a[172:175], v[164:167], v[228:231]
    v_mfma_f32_16x16x32_bf16 v[232:235], a[180:183], v[164:167], v[232:235]
    v_mfma_f32_16x16x32_bf16 v[236:239], a[188:191], v[164:167], v[236:239]
    s_nop 4
    v_mov_b32_dpp v168, v224 quad_perm:[0,0,0,0] row_mask:0xf bank_mask:0xf
    v_mov_b32_dpp v169, v228 quad_perm:[0,0,0,0] row_mask:0xf bank_mask:0xf
    v_mov_b32_dpp v170, v232 quad_perm:[0,0,0,0] row_mask:0xf bank_mask:0xf
    v_mov_b32_dpp v171, v236 quad_perm:[0,0,0,0] row_mask:0xf bank_mask:0xf
    v_add_f32_dpp v168, v225, v168 quad_perm:[1,1,1,1] row_mask:0xf bank_mask:0xf
    v_add_f32_dpp v169, v229, v169 quad_perm:[1,1,1,1] row_mask:0xf bank_mask:0xf
    v_add_f32_dpp v170, v233, v170 quad_perm:[1,1,1,1] row_mask:0xf bank_mask:0xf
    v_add_f32_dpp v171, v237, v171 quad_perm:[1,1,1,1] row_mask:0xf bank_mask:0xf
    v_add_f32_dpp v168, v226, v168 quad_perm:[2,2,2,2] row_mask:0xf bank_mask:0xf
    v_add_f32_dpp v169, v230, v169 quad_perm:[2,2,2,2] row_mask:0xf bank_mask:0xf
    v_add_f32_dpp v170, v234, v170 quad_perm:[2,2,2,2] row_mask:0xf bank_mask:0xf
    v_add_f32_dpp v171, v238, v171 quad_perm:[2,2,2,2] row_mask:0xf bank_mask:0xf
    v_add_f32_dpp v168, v227, v168 quad_perm:[3,3,3,3] row_mask:0xf bank_mask:0xf
    v_add_f32_dpp v169, v231, v169 quad_perm:[3,3,3,3] row_mask:0xf bank_mask:0xf
    v_add_f32_dpp v170, v235, v170 quad_perm:[3,3,3,3] row_mask:0xf bank_mask:0xf
    v_add_f32_dpp v171, v239, v171 quad_perm:[3,3,3,3] row_mask:0xf bank_mask:0xf
    v_max3_f32 v18, v168, v169, v18
    v_max3_f32 v18, v170, v171, v18
    v_cvt_pk_bf16_f32 v210, v168, v169
    v_cvt_pk_bf16_f32 v211, v170, v171
    s_waitcnt vmcnt(17)
    s_add_u32 m0, s61, 20064
    s_add_u32 s60, s7, 68608
    buffer_load_dwordx4 v3, s[16:19], s60 offen nt lds
    s_add_u32 m0, s61, 33792
    s_add_u32 s60, s63, 175616
    buffer_load_dwordx4 v6, s[24:27], s60 offen lds
    v_mfma_f32_16x16x32_bf16 v[224:227], a[192:195], v[160:163], 0
    v_mfma_f32_16x16x32_bf16 v[228:231], a[200:203], v[160:163], 0
    v_mfma_f32_16x16x32_bf16 v[232:235], a[208:211], v[160:163], 0
    v_mfma_f32_16x16x32_bf16 v[236:239], a[216:219], v[160:163], 0
    v_mfma_f32_16x16x32_bf16 v[224:227], a[196:199], v[164:167], v[224:227]
    v_mfma_f32_16x16x32_bf16 v[228:231], a[204:207], v[164:167], v[228:231]
    v_mfma_f32_16x16x32_bf16 v[232:235], a[212:215], v[164:167], v[232:235]
    v_mfma_f32_16x16x32_bf16 v[236:239], a[220:223], v[164:167], v[236:239]
    s_nop 4
    v_mov_b32_dpp v168, v224 quad_perm:[0,0,0,0] row_mask:0xf bank_mask:0xf
    v_mov_b32_dpp v169, v228 quad_perm:[0,0,0,0] row_mask:0xf bank_mask:0xf
    v_mov_b32_dpp v170, v232 quad_perm:[0,0,0,0] row_mask:0xf bank_mask:0xf
    v_mov_b32_dpp v171, v236 quad_perm:[0,0,0,0] row_mask:0xf bank_mask:0xf
    v_add_f32_dpp v168, v225, v168 quad_perm:[1,1,1,1] row_mask:0xf bank_mask:0xf
    v_add_f32_dpp v169, v229, v169 quad_perm:[1,1,1,1] row_mask:0xf bank_mask:0xf
    v_add_f32_dpp v170, v233, v170 quad_perm:[1,1,1,1] row_mask:0xf bank_mask:0xf
    v_add_f32_dpp v171, v237, v171 quad_perm:[1,1,1,1] row_mask:0xf bank_mask:0xf
    v_add_f32_dpp v168, v226, v168 quad_perm:[2,2,2,2] row_mask:0xf bank_mask:0xf
    v_add_f32_dpp v169, v230, v169 quad_perm:[2,2,2,2] row_mask:0xf bank_mask:0xf
    v_add_f32_dpp v170, v234, v170 quad_perm:[2,2,2,2] row_mask:0xf bank_mask:0xf
    v_add_f32_dpp v171, v238, v171 quad_perm:[2,2,2,2] row_mask:0xf bank_mask:0xf
    v_add_f32_dpp v168, v227, v168 quad_perm:[3,3,3,3] row_mask:0xf bank_mask:0xf
    v_add_f32_dpp v169, v231, v169 quad_perm:[3,3,3,3] row_mask:0xf bank_mask:0xf
    v_add_f32_dpp v170, v235, v170 quad_perm:[3,3,3,3] row_mask:0xf bank_mask:0xf
    v_add_f32_dpp v171, v239, v171 quad_perm:[3,3,3,3] row_mask:0xf bank_mask:0xf
    v_max3_f32 v18, v168, v169, v18
    v_max3_f32 v18, v170, v171, v18
    v_cvt_pk_bf16_f32 v212, v168, v169
    v_cvt_pk_bf16_f32 v213, v170, v171
    s_waitcnt vmcnt(18)
    s_add_u32 m0, s61, 21120
    s_add_u32 s60, s7, 81920
    buffer_load_dwordx4 v3, s[16:19], s60 offen nt lds
    v_mfma_f32_16x16x32_bf16 v[224:227], a[224:227], v[160:163], 0
    v_mfma_f32_16x16x32_bf16 v[228:231], a[232:235], v[160:163], 0
    v_mfma_f32_16x16x32_bf16 v[232:235], a[240:243], v[160:163], 0
    v_mfma_f32_16x16x32_bf16 v[236:239], a[248:251], v[160:163], 0
    v_mfma_f32_16x16x32_bf16 v[224:227], a[228:231], v[164:167], v[224:227]
    v_mfma_f32_16x16x32_bf16 v[228:231], a[236:239], v[164:167], v[228:231]
    v_mfma_f32_16x16x32_bf16 v[232:235], a[244:247], v[164:167], v[232:235]
    v_mfma_f32_16x16x32_bf16 v[236:239], a[252:255], v[164:167], v[236:239]
    s_nop 4
    v_mov_b32_dpp v168, v224 quad_perm:[0,0,0,0] row_mask:0xf bank_mask:0xf
    v_mov_b32_dpp v169, v228 quad_perm:[0,0,0,0] row_mask:0xf bank_mask:0xf
    v_mov_b32_dpp v170, v232 quad_perm:[0,0,0,0] row_mask:0xf bank_mask:0xf
    v_mov_b32_dpp v171, v236 quad_perm:[0,0,0,0] row_mask:0xf bank_mask:0xf
    v_add_f32_dpp v168, v225, v168 quad_perm:[1,1,1,1] row_mask:0xf bank_mask:0xf
    v_add_f32_dpp v169, v229, v169 quad_perm:[1,1,1,1] row_mask:0xf bank_mask:0xf
    v_add_f32_dpp v170, v233, v170 quad_perm:[1,1,1,1] row_mask:0xf bank_mask:0xf
    v_add_f32_dpp v171, v237, v171 quad_perm:[1,1,1,1] row_mask:0xf bank_mask:0xf
    v_add_f32_dpp v168, v226, v168 quad_perm:[2,2,2,2] row_mask:0xf bank_mask:0xf
    v_add_f32_dpp v169, v230, v169 quad_perm:[2,2,2,2] row_mask:0xf bank_mask:0xf
    v_add_f32_dpp v170, v234, v170 quad_perm:[2,2,2,2] row_mask:0xf bank_mask:0xf
    v_add_f32_dpp v171, v238, v171 quad_perm:[2,2,2,2] row_mask:0xf bank_mask:0xf
    v_add_f32_dpp v168, v227, v168 quad_perm:[3,3,3,3] row_mask:0xf bank_mask:0xf
    v_add_f32_dpp v169, v231, v169 quad_perm:[3,3,3,3] row_mask:0xf bank_mask:0xf
    v_add_f32_dpp v170, v235, v170 quad_perm:[3,3,3,3] row_mask:0xf bank_mask:0xf
    v_add_f32_dpp v171, v239, v171 quad_perm:[3,3,3,3] row_mask:0xf bank_mask:0xf
    v_max3_f32 v18, v168, v169, v18
    v_max3_f32 v18, v170, v171, v18
    v_cvt_pk_bf16_f32 v214, v168, v169
    v_cvt_pk_bf16_f32 v215, v170, v171
    s_waitcnt vmcnt(17)
    s_add_u32 m0, s61, 22176
    s_add_u32 s60, s7, 82944
    buffer_load_dwordx4 v3, s[16:19], s60 offen nt lds
    s_add_u32 m0, s61, 34848
    s_add_u32 s60, s63, 189952
    buffer_load_dwordx4 v6, s[24:27], s60 offen lds
    v_mfma_f32_16x16x32_bf16 v[224:227], v[32:35], v[160:163], 0
    v_mfma_f32_16x16x32_bf16 v[228:231], v[40:43], v[160:163], 0
    v_mfma_f32_16x16x32_bf16 v[232:235], v[48:51], v[160:163], 0
    v_mfma_f32_16x16x32_bf16 v[236:239], v[56:59], v[160:163], 0
    v_mfma_f32_16x16x32_bf16 v[224:227], v[36:39], v[164:167], v[224:227]
    v_mfma_f32_16x16x32_bf16 v[228:231], v[44:47], v[164:167], v[228:231]
    v_mfma_f32_16x16x32_bf16 v[232:235], v[52:55], v[164:167], v[232:235]
    v_mfma_f32_16x16x32_bf16 v[236:239], v[60:63], v[164:167], v[236:239]
    s_nop 4
    v_mov_b32_dpp v168, v224 quad_perm:[0,0,0,0] row_mask:0xf bank_mask:0xf
    v_mov_b32_dpp v169, v228 quad_perm:[0,0,0,0] row_mask:0xf bank_mask:0xf
    v_mov_b32_dpp v170, v232 quad_perm:[0,0,0,0] row_mask:0xf bank_mask:0xf
    v_mov_b32_dpp v171, v236 quad_perm:[0,0,0,0] row_mask:0xf bank_mask:0xf
    v_add_f32_dpp v168, v225, v168 quad_perm:[1,1,1,1] row_mask:0xf bank_mask:0xf
    v_add_f32_dpp v169, v229, v169 quad_perm:[1,1,1,1] row_mask:0xf bank_mask:0xf
    v_add_f32_dpp v170, v233, v170 quad_perm:[1,1,1,1] row_mask:0xf bank_mask:0xf
    v_add_f32_dpp v171, v237, v171 quad_perm:[1,1,1,1] row_mask:0xf bank_mask:0xf
    v_add_f32_dpp v168, v226, v168 quad_perm:[2,2,2,2] row_mask:0xf bank_mask:0xf
    v_add_f32_dpp v169, v230, v169 quad_perm:[2,2,2,2] row_mask:0xf bank_mask:0xf
    v_add_f32_dpp v170, v234, v170 quad_perm:[2,2,2,2] row_mask:0xf bank_mask:0xf
    v_add_f32_dpp v171, v238, v171 quad_perm:[2,2,2,2] row_mask:0xf bank_mask:0xf
    v_add_f32_dpp v168, v227, v168 quad_perm:[3,3,3,3] row_mask:0xf bank_mask:0xf
    v_add_f32_dpp v169, v231, v169 quad_perm:[3,3,3,3] row_mask:0xf bank_mask:0xf
    v_add_f32_dpp v170, v235, v170 quad_perm:[3,3,3,3] row_mask:0xf bank_mask:0xf
    v_add_f32_dpp v171, v239, v171 quad_perm:[3,3,3,3] row_mask:0xf bank_mask:0xf
    v_max3_f32 v18, v168, v169, v18
    v_max3_f32 v18, v170, v171, v18
    v_cvt_pk_bf16_f32 v192, v168, v169
    v_cvt_pk_bf16_f32 v193, v170, v171
    s_waitcnt vmcnt(18)
    s_add_u32 m0, s61, 23232
    s_add_u32 s60, s7, 83968
    buffer_load_dwordx4 v3, s[16:19], s60 offen nt lds
    v_mfma_f32_16x16x32_bf16 v[224:227], v[64:67], v[160:163], 0
    v_mfma_f32_16x16x32_bf16 v[228:231], v[72:75], v[160:163], 0
    v_mfma_f32_16x16x32_bf16 v[232:235], v[80:83], v[160:163], 0
    v_mfma_f32_16x16x32_bf16 v[236:239], v[88:91], v[160:163], 0
    v_mfma_f32_16x16x32_bf16 v[224:227], v[68:71], v[164:167], v[224:227]
    v_mfma_f32_16x16x32_bf16 v[228:231], v[76:79], v[164:167], v[228:231]
    v_mfma_f32_16x16x32_bf16 v[232:235], v[84:87], v[164:167], v[232:235]
    v_mfma_f32_16x16x32_bf16 v[236:239], v[92:95], v[164:167], v[236:239]
    s_nop 4
    v_mov_b32_dpp v168, v224 quad_perm:[0,0,0,0] row_mask:0xf bank_mask:0xf
    v_mov_b32_dpp v169, v228 quad_perm:[0,0,0,0] row_mask:0xf bank_mask:0xf
    v_mov_b32_dpp v170, v232 quad_perm:[0,0,0,0] row_mask:0xf bank_mask:0xf
    v_mov_b32_dpp v171, v236 quad_perm:[0,0,0,0] row_mask:0xf bank_mask:0xf
    v_add_f32_dpp v168, v225, v168 quad_perm:[1,1,1,1] row_mask:0xf bank_mask:0xf
    v_add_f32_dpp v169, v229, v169 quad_perm:[1,1,1,1] row_mask:0xf bank_mask:0xf
    v_add_f32_dpp v170, v233, v170 quad_perm:[1,1,1,1] row_mask:0xf bank_mask:0xf
    v_add_f32_dpp v171, v237, v171 quad_perm:[1,1,1,1] row_mask:0xf bank_mask:0xf
    v_add_f32_dpp v168, v226, v168 quad_perm:[2,2,2,2] row_mask:0xf bank_mask:0xf
    v_add_f32_dpp v169, v230, v169 quad_perm:[2,2,2,2] row_mask:0xf bank_mask:0xf
    v_add_f32_dpp v170, v234, v170 quad_perm:[2,2,2,2] row_mask:0xf bank_mask:0xf
    v_add_f32_dpp v171, v238, v171 quad_perm:[2,2,2,2] row_mask:0xf bank_mask:0xf
    v_add_f32_dpp v168, v227, v168 quad_perm:[3,3,3,3] row_mask:0xf bank_mask:0xf
    v_add_f32_dpp v169, v231, v169 quad_perm:[3,3,3,3] row_mask:0xf bank_mask:0xf
    v_add_f32_dpp v170, v235, v170 quad_perm:[3,3,3,3] row_mask:0xf bank_mask:0xf
    v_add_f32_dpp v171, v239, v171 quad_perm:[3,3,3,3] row_mask:0xf bank_mask:0xf
    v_max3_f32 v18, v168, v169, v18
    v_max3_f32 v18, v170, v171, v18
    v_cvt_pk_bf16_f32 v194, v168, v169
    v_cvt_pk_bf16_f32 v195, v170, v171
    s_waitcnt vmcnt(17)
    s_add_u32 m0, s61, 24288
    s_add_u32 s60, s7, 84992
    buffer_load_dwordx4 v3, s[16:19], s60 offen nt lds
    s_add_u32 m0, s61, 35904
    s_add_u32 s60, s63, 204288
    buffer_load_dwordx4 v6, s[24:27], s60 offen lds
    ds_read_b64_tr_b16 a[226:227], v11 offset:25344
    ds_read_b64_tr_b16 a[230:231], v11 offset:25376
    ds_read_b64_tr_b16 a[234:235], v11 offset:25408
    ds_read_b64_tr_b16 a[238:239], v11 offset:25440
    ds_read_b64_tr_b16 a[242:243], v12 offset:25472
    ds_read_b64_tr_b16 a[246:247], v12 offset:25504
    ds_read_b64_tr_b16 a[250:251], v12 offset:25536
    ds_read_b64_tr_b16 a[254:255], v12 offset:25568
    s_waitcnt lgkmcnt(0)
    v_mfma_f32_16x16x32_bf16 v[224:227], v[96:99], v[160:163], 0
    v_mfma_f32_16x16x32_bf16 v[228:231], v[104:107], v[160:163], 0
    v_mfma_f32_16x16x32_bf16 v[232:235], v[112:115], v[160:163], 0
    v_mfma_f32_16x16x32_bf16 v[236:239], v[120:123], v[160:163], 0
    v_mfma_f32_16x16x32_bf16 v[224:227], v[100:103], v[164:167], v[224:227]
    v_mfma_f32_16x16x32_bf16 v[228:231], v[108:111], v[164:167], v[228:231]
    v_mfma_f32_16x16x32_bf16 v[232:235], v[116:119], v[164:167], v[232:235]
    v_mfma_f32_16x16x32_bf16 v[236:239], v[124:127], v[164:167], v[236:239]
    s_nop 4
    v_mov_b32_dpp v168, v224 quad_perm:[0,0,0,0] row_mask:0xf bank_mask:0xf
    v_mov_b32_dpp v169, v228 quad_perm:[0,0,0,0] row_mask:0xf bank_mask:0xf
    v_mov_b32_dpp v170, v232 quad_perm:[0,0,0,0] row_mask:0xf bank_mask:0xf
    v_mov_b32_dpp v171, v236 quad_perm:[0,0,0,0] row_mask:0xf bank_mask:0xf
    v_add_f32_dpp v168, v225, v168 quad_perm:[1,1,1,1] row_mask:0xf bank_mask:0xf
    v_add_f32_dpp v169, v229, v169 quad_perm:[1,1,1,1] row_mask:0xf bank_mask:0xf
    v_add_f32_dpp v170, v233, v170 quad_perm:[1,1,1,1] row_mask:0xf bank_mask:0xf
    v_add_f32_dpp v171, v237, v171 quad_perm:[1,1,1,1] row_mask:0xf bank_mask:0xf
    v_add_f32_dpp v168, v226, v168 quad_perm:[2,2,2,2] row_mask:0xf bank_mask:0xf
    v_add_f32_dpp v169, v230, v169 quad_perm:[2,2,2,2] row_mask:0xf bank_mask:0xf
    v_add_f32_dpp v170, v234, v170 quad_perm:[2,2,2,2] row_mask:0xf bank_mask:0xf
    v_add_f32_dpp v171, v238, v171 quad_perm:[2,2,2,2] row_mask:0xf bank_mask:0xf
    v_add_f32_dpp v168, v227, v168 quad_perm:[3,3,3,3] row_mask:0xf bank_mask:0xf
    v_add_f32_dpp v169, v231, v169 quad_perm:[3,3,3,3] row_mask:0xf bank_mask:0xf
    v_add_f32_dpp v170, v235, v170 quad_perm:[3,3,3,3] row_mask:0xf bank_mask:0xf
    v_add_f32_dpp v171, v239, v171 quad_perm:[3,3,3,3] row_mask:0xf bank_mask:0xf
    v_max3_f32 v18, v168, v169, v18
    v_max3_f32 v18, v170, v171, v18
    v_cvt_pk_bf16_f32 v196, v168, v169
    v_cvt_pk_bf16_f32 v197, v170, v171
    s_waitcnt vmcnt(18)
    s_add_u32 s101, s7, 393216
    buffer_load_dwordx4 a[0:3], v2, s[12:15], s101 offen offset:0 nt
    v_mfma_f32_16x16x32_bf16 v[224:227], v[128:131], v[160:163], 0
    v_mfma_f32_16x16x32_bf16 v[228:231], v[136:139], v[160:163], 0
    v_mfma_f32_16x16x32_bf16 v[232:235], v[144:147], v[160:163], 0
    v_mfma_f32_16x16x32_bf16 v[236:239], v[152:155], v[160:163], 0
    v_mfma_f32_16x16x32_bf16 v[224:227], v[132:135], v[164:167], v[224:227]
    v_mfma_f32_16x16x32_bf16 v[228:231], v[140:143], v[164:167], v[228:231]
    v_mfma_f32_16x16x32_bf16 v[232:235], v[148:151], v[164:167], v[232:235]
    v_mfma_f32_16x16x32_bf16 v[236:239], v[156:159], v[164:167], v[236:239]
    s_nop 4
    v_mov_b32_dpp v168, v224 quad_perm:[0,0,0,0] row_mask:0xf bank_mask:0xf
    v_mov_b32_dpp v169, v228 quad_perm:[0,0,0,0] row_mask:0xf bank_mask:0xf
    v_mov_b32_dpp v170, v232 quad_perm:[0,0,0,0] row_mask:0xf bank_mask:0xf
    v_mov_b32_dpp v171, v236 quad_perm:[0,0,0,0] row_mask:0xf bank_mask:0xf
    v_add_f32_dpp v168, v225, v168 quad_perm:[1,1,1,1] row_mask:0xf bank_mask:0xf
    v_add_f32_dpp v169, v229, v169 quad_perm:[1,1,1,1] row_mask:0xf bank_mask:0xf
    v_add_f32_dpp v170, v233, v170 quad_perm:[1,1,1,1] row_mask:0xf bank_mask:0xf
    v_add_f32_dpp v171, v237, v171 quad_perm:[1,1,1,1] row_mask:0xf bank_mask:0xf
    v_add_f32_dpp v168, v226, v168 quad_perm:[2,2,2,2] row_mask:0xf bank_mask:0xf
    v_add_f32_dpp v169, v230, v169 quad_perm:[2,2,2,2] row_mask:0xf bank_mask:0xf
    v_add_f32_dpp v170, v234, v170 quad_perm:[2,2,2,2] row_mask:0xf bank_mask:0xf
    v_add_f32_dpp v171, v238, v171 quad_perm:[2,2,2,2] row_mask:0xf bank_mask:0xf
    v_add_f32_dpp v168, v227, v168 quad_perm:[3,3,3,3] row_mask:0xf bank_mask:0xf
    v_add_f32_dpp v169, v231, v169 quad_perm:[3,3,3,3] row_mask:0xf bank_mask:0xf
    v_add_f32_dpp v170, v235, v170 quad_perm:[3,3,3,3] row_mask:0xf bank_mask:0xf
    v_add_f32_dpp v171, v239, v171 quad_perm:[3,3,3,3] row_mask:0xf bank_mask:0xf
    v_max3_f32 v18, v168, v169, v18
    v_max3_f32 v18, v170, v171, v18
    v_cvt_pk_bf16_f32 v198, v168, v169
    v_cvt_pk_bf16_f32 v199, v170, v171
    v_mov_b32 v22, v18
    s_nop 1
    v_permlane16_swap_b32 v22, v18
    v_max_f32 v18, v18, v22
    v_mov_b32 v22, v18
    s_nop 1
    v_permlane32_swap_b32 v22, v18
    v_max_f32 v18, v18, v22
    v_cvt_pk_bf16_f32 v18, v18, v18
    v_and_b32 v18, 0xffff0000, v18
    v_mul_f32 v18, s94, v18
    s_waitcnt vmcnt(17)
    buffer_load_dwordx4 a[4:7], v2, s[12:15], s101 offen offset:256 nt
    s_add_u32 m0, s61, 36960
    s_add_u32 s60, s63, 218624
    buffer_load_dwordx4 v6, s[24:27], s60 offen lds
    v_lshlrev_b32 v224, 16, v192
    v_and_b32 v225, 0xffff0000, v192
    v_fma_f32 v224, v224, s94, -v18
    v_fma_f32 v225, v225, s94, -v18
    v_exp_f32 v224, v224
    v_exp_f32 v225, v225
    v_lshlrev_b32 v226, 16, v193
    v_and_b32 v227, 0xffff0000, v193
    v_fma_f32 v226, v226, s94, -v18
    v_fma_f32 v227, v227, s94, -v18
    v_exp_f32 v226, v226
    v_exp_f32 v227, v227
    v_lshlrev_b32 v228, 16, v194
    v_and_b32 v229, 0xffff0000, v194
    v_fma_f32 v228, v228, s94, -v18
    v_fma_f32 v229, v229, s94, -v18
    v_exp_f32 v228, v228
    v_exp_f32 v229, v229
    v_lshlrev_b32 v230, 16, v195
    v_and_b32 v231, 0xffff0000, v195
    v_fma_f32 v230, v230, s94, -v18
    v_fma_f32 v231, v231, s94, -v18
    v_exp_f32 v230, v230
    v_exp_f32 v231, v231
    v_pk_add_f32 v[20:21], v[224:225], 0
    v_cvt_pk_bf16_f32 v192, v224, v225
    v_pk_add_f32 v[20:21], v[20:21], v[226:227]
    v_cvt_pk_bf16_f32 v193, v226, v227
    v_pk_add_f32 v[20:21], v[20:21], v[228:229]
    v_cvt_pk_bf16_f32 v194, v228, v229
    v_pk_add_f32 v[20:21], v[20:21], v[230:231]
    v_cvt_pk_bf16_f32 v195, v230, v231
    s_waitcnt vmcnt(18)
    buffer_load_dwordx4 a[8:11], v2, s[12:15], s101 offen offset:2048 nt
    v_lshlrev_b32 v224, 16, v196
    v_and_b32 v225, 0xffff0000, v196
    v_fma_f32 v224, v224, s94, -v18
    v_fma_f32 v225, v225, s94, -v18
    v_exp_f32 v224, v224
    v_exp_f32 v225, v225
    v_lshlrev_b32 v226, 16, v197
    v_and_b32 v227, 0xffff0000, v197
    v_fma_f32 v226, v226, s94, -v18
    v_fma_f32 v227, v227, s94, -v18
    v_exp_f32 v226, v226
    v_exp_f32 v227, v227
    v_lshlrev_b32 v228, 16, v198
    v_and_b32 v229, 0xffff0000, v198
    v_fma_f32 v228, v228, s94, -v18
    v_fma_f32 v229, v229, s94, -v18
    v_exp_f32 v228, v228
    v_exp_f32 v229, v229
    v_lshlrev_b32 v230, 16, v199
    v_and_b32 v231, 0xffff0000, v199
    v_fma_f32 v230, v230, s94, -v18
    v_fma_f32 v231, v231, s94, -v18
    v_exp_f32 v230, v230
    v_exp_f32 v231, v231
    v_pk_add_f32 v[20:21], v[20:21], v[224:225]
    v_cvt_pk_bf16_f32 v196, v224, v225
    v_pk_add_f32 v[20:21], v[20:21], v[226:227]
    v_cvt_pk_bf16_f32 v197, v226, v227
    v_pk_add_f32 v[20:21], v[20:21], v[228:229]
    v_cvt_pk_bf16_f32 v198, v228, v229
    v_pk_add_f32 v[20:21], v[20:21], v[230:231]
    v_cvt_pk_bf16_f32 v199, v230, v231
    s_waitcnt vmcnt(17)
    buffer_load_dwordx4 a[12:15], v2, s[12:15], s101 offen offset:2304 nt
    s_add_u32 m0, s61, 25344
    s_add_u32 s60, s63, 118272
    buffer_load_dwordx4 v6, s[24:27], s60 offen lds
    v_lshlrev_b32 v224, 16, v200
    v_and_b32 v225, 0xffff0000, v200
    v_fma_f32 v224, v224, s94, -v18
    v_fma_f32 v225, v225, s94, -v18
    v_exp_f32 v224, v224
    v_exp_f32 v225, v225
    v_lshlrev_b32 v226, 16, v201
    v_and_b32 v227, 0xffff0000, v201
    v_fma_f32 v226, v226, s94, -v18
    v_fma_f32 v227, v227, s94, -v18
    v_exp_f32 v226, v226
    v_exp_f32 v227, v227
    v_lshlrev_b32 v228, 16, v202
    v_and_b32 v229, 0xffff0000, v202
    v_fma_f32 v228, v228, s94, -v18
    v_fma_f32 v229, v229, s94, -v18
    v_exp_f32 v228, v228
    v_exp_f32 v229, v229
    v_lshlrev_b32 v230, 16, v203
    v_and_b32 v231, 0xffff0000, v203
    v_fma_f32 v230, v230, s94, -v18
    v_fma_f32 v231, v231, s94, -v18
    v_exp_f32 v230, v230
    v_exp_f32 v231, v231
    v_pk_add_f32 v[20:21], v[20:21], v[224:225]
    v_cvt_pk_bf16_f32 v200, v224, v225
    v_pk_add_f32 v[20:21], v[20:21], v[226:227]
    v_cvt_pk_bf16_f32 v201, v226, v227
    v_pk_add_f32 v[20:21], v[20:21], v[228:229]
    v_cvt_pk_bf16_f32 v202, v228, v229
    v_pk_add_f32 v[20:21], v[20:21], v[230:231]
    v_cvt_pk_bf16_f32 v203, v230, v231
    s_waitcnt vmcnt(17)
    s_add_u32 s101, s7, 409600
    buffer_load_dwordx4 a[16:19], v2, s[12:15], s101 offen offset:0 nt
    v_lshlrev_b32 v224, 16, v204
    v_and_b32 v225, 0xffff0000, v204
    v_fma_f32 v224, v224, s94, -v18
    v_fma_f32 v225, v225, s94, -v18
    v_exp_f32 v224, v224
    v_exp_f32 v225, v225
    v_lshlrev_b32 v226, 16, v205
    v_and_b32 v227, 0xffff0000, v205
    v_fma_f32 v226, v226, s94, -v18
    v_fma_f32 v227, v227, s94, -v18
    v_exp_f32 v226, v226
    v_exp_f32 v227, v227
    v_lshlrev_b32 v228, 16, v206
    v_and_b32 v229, 0xffff0000, v206
    v_fma_f32 v228, v228, s94, -v18
    v_fma_f32 v229, v229, s94, -v18
    v_exp_f32 v228, v228
    v_exp_f32 v229, v229
    v_lshlrev_b32 v230, 16, v207
    v_and_b32 v231, 0xffff0000, v207
    v_fma_f32 v230, v230, s94, -v18
    v_fma_f32 v231, v231, s94, -v18
    v_exp_f32 v230, v230
    v_exp_f32 v231, v231
    v_pk_add_f32 v[20:21], v[20:21], v[224:225]
    v_cvt_pk_bf16_f32 v204, v224, v225
    v_pk_add_f32 v[20:21], v[20:21], v[226:227]
    v_cvt_pk_bf16_f32 v205, v226, v227
    v_pk_add_f32 v[20:21], v[20:21], v[228:229]
    v_cvt_pk_bf16_f32 v206, v228, v229
    v_pk_add_f32 v[20:21], v[20:21], v[230:231]
    v_cvt_pk_bf16_f32 v207, v230, v231
    s_waitcnt vmcnt(17)
    buffer_load_dwordx4 a[20:23], v2, s[12:15], s101 offen offset:256 nt
    s_add_u32 m0, s61, 26400
    s_add_u32 s60, s63, 132608
    buffer_load_dwordx4 v6, s[24:27], s60 offen lds
    v_lshlrev_b32 v224, 16, v208
    v_and_b32 v225, 0xffff0000, v208
    v_fma_f32 v224, v224, s94, -v18
    v_fma_f32 v225, v225, s94, -v18
    v_exp_f32 v224, v224
    v_exp_f32 v225, v225
    v_lshlrev_b32 v226, 16, v209
    v_and_b32 v227, 0xffff0000, v209
    v_fma_f32 v226, v226, s94, -v18
    v_fma_f32 v227, v227, s94, -v18
    v_exp_f32 v226, v226
    v_exp_f32 v227, v227
    v_lshlrev_b32 v228, 16, v210
    v_and_b32 v229, 0xffff0000, v210
    v_fma_f32 v228, v228, s94, -v18
    v_fma_f32 v229, v229, s94, -v18
    v_exp_f32 v228, v228
    v_exp_f32 v229, v229
    v_lshlrev_b32 v230, 16, v211
    v_and_b32 v231, 0xffff0000, v211
    v_fma_f32 v230, v230, s94, -v18
    v_fma_f32 v231, v231, s94, -v18
    v_exp_f32 v230, v230
    v_exp_f32 v231, v231
    v_pk_add_f32 v[20:21], v[20:21], v[224:225]
    v_cvt_pk_bf16_f32 v208, v224, v225
    v_pk_add_f32 v[20:21], v[20:21], v[226:227]
    v_cvt_pk_bf16_f32 v209, v226, v227
    v_pk_add_f32 v[20:21], v[20:21], v[228:229]
    v_cvt_pk_bf16_f32 v210, v228, v229
    v_pk_add_f32 v[20:21], v[20:21], v[230:231]
    v_cvt_pk_bf16_f32 v211, v230, v231
    s_waitcnt vmcnt(17)
    buffer_load_dwordx4 a[24:27], v2, s[12:15], s101 offen offset:2048 nt
    ds_read_b64_tr_b16 a[224:225], v11 offset:29568
    ds_read_b64_tr_b16 a[228:229], v11 offset:29600
    ds_read_b64_tr_b16 a[232:233], v11 offset:29632
    ds_read_b64_tr_b16 a[236:237], v11 offset:29664
    ds_read_b64_tr_b16 a[240:241], v12 offset:29696
    ds_read_b64_tr_b16 a[244:245], v12 offset:29728
    ds_read_b64_tr_b16 a[248:249], v12 offset:29760
    ds_read_b64_tr_b16 a[252:253], v12 offset:29792
    s_waitcnt lgkmcnt(0)
    v_lshlrev_b32 v224, 16, v212
    v_and_b32 v225, 0xffff0000, v212
    v_fma_f32 v224, v224, s94, -v18
    v_fma_f32 v225, v225, s94, -v18
    v_exp_f32 v224, v224
    v_exp_f32 v225, v225
    v_lshlrev_b32 v226, 16, v213
    v_and_b32 v227, 0xffff0000, v213
    v_fma_f32 v226, v226, s94, -v18
    v_fma_f32 v227, v227, s94, -v18
    v_exp_f32 v226, v226
    v_exp_f32 v227, v227
    v_lshlrev_b32 v228, 16, v214
    v_and_b32 v229, 0xffff0000, v214
    v_fma_f32 v228, v228, s94, -v18
    v_fma_f32 v229, v229, s94, -v18
    v_exp_f32 v228, v228
    v_exp_f32 v229, v229
    v_lshlrev_b32 v230, 16, v215
    v_and_b32 v231, 0xffff0000, v215
    v_fma_f32 v230, v230, s94, -v18
    v_fma_f32 v231, v231, s94, -v18
    v_exp_f32 v230, v230
    v_exp_f32 v231, v231
    v_pk_add_f32 v[20:21], v[20:21], v[224:225]
    v_cvt_pk_bf16_f32 v212, v224, v225
    v_pk_add_f32 v[20:21], v[20:21], v[226:227]
    v_cvt_pk_bf16_f32 v213, v226, v227
    v_pk_add_f32 v[20:21], v[20:21], v[228:229]
    v_cvt_pk_bf16_f32 v214, v228, v229
    v_pk_add_f32 v[20:21], v[20:21], v[230:231]
    v_cvt_pk_bf16_f32 v215, v230, v231
    s_waitcnt vmcnt(17)
    buffer_load_dwordx4 a[28:31], v2, s[12:15], s101 offen offset:2304 nt
    s_add_u32 m0, s61, 27456
    s_add_u32 s60, s63, 146944
    buffer_load_dwordx4 v6, s[24:27], s60 offen lds
    ds_read_b64_tr_b16 v[96:97], v13 offset:0
    ds_read_b64_tr_b16 v[98:99], v14 offset:32
    ds_read_b64_tr_b16 v[100:101], v13 offset:64
    ds_read_b64_tr_b16 v[102:103], v14 offset:96
    ds_read_b64_tr_b16 v[104:105], v13 offset:128
    ds_read_b64_tr_b16 v[106:107], v14 offset:160
    ds_read_b64_tr_b16 v[108:109], v13 offset:192
    ds_read_b64_tr_b16 v[110:111], v14 offset:224
    ds_read_b64_tr_b16 v[112:113], v13 offset:256
    ds_read_b64_tr_b16 v[114:115], v14 offset:288
    ds_read_b64_tr_b16 v[116:117], v13 offset:320
    ds_read_b64_tr_b16 v[118:119], v14 offset:352
    ds_read_b64_tr_b16 v[120:121], v13 offset:384
    ds_read_b64_tr_b16 v[122:123], v14 offset:416
    ds_read_b64_tr_b16 v[124:125], v13 offset:448
    ds_read_b64_tr_b16 v[126:127], v14 offset:480
    s_waitcnt lgkmcnt(12)
    v_mfma_f32_16x16x16_bf16 v[32:35], v[192:193], v[96:97], 0
    v_mfma_f32_16x16x16_bf16 v[36:39], v[192:193], v[98:99], 0
    v_mfma_f32_16x16x16_bf16 v[40:43], v[192:193], v[100:101], 0
    v_mfma_f32_16x16x16_bf16 v[44:47], v[192:193], v[102:103], 0
    s_waitcnt lgkmcnt(8)
    v_mfma_f32_16x16x16_bf16 v[48:51], v[192:193], v[104:105], 0
    v_mfma_f32_16x16x16_bf16 v[52:55], v[192:193], v[106:107], 0
    v_mfma_f32_16x16x16_bf16 v[56:59], v[192:193], v[108:109], 0
    v_mfma_f32_16x16x16_bf16 v[60:63], v[192:193], v[110:111], 0
    s_waitcnt lgkmcnt(4)
    v_mfma_f32_16x16x16_bf16 v[64:67], v[192:193], v[112:113], 0
    v_mfma_f32_16x16x16_bf16 v[68:71], v[192:193], v[114:115], 0
    v_mfma_f32_16x16x16_bf16 v[72:75], v[192:193], v[116:117], 0
    v_mfma_f32_16x16x16_bf16 v[76:79], v[192:193], v[118:119], 0
    s_waitcnt lgkmcnt(0)
    v_mfma_f32_16x16x16_bf16 v[80:83], v[192:193], v[120:121], 0
    v_mfma_f32_16x16x16_bf16 v[84:87], v[192:193], v[122:123], 0
    v_mfma_f32_16x16x16_bf16 v[88:91], v[192:193], v[124:125], 0
    v_mfma_f32_16x16x16_bf16 v[92:95], v[192:193], v[126:127], 0
    s_waitcnt vmcnt(17)
    s_add_u32 s101, s7, 425984
    buffer_load_dwordx4 a[32:35], v2, s[12:15], s101 offen offset:0 nt
    ds_read_b64_tr_b16 v[96:97], v13 offset:8448
    ds_read_b64_tr_b16 v[98:99], v14 offset:8480
    ds_read_b64_tr_b16 v[100:101], v13 offset:8512
    ds_read_b64_tr_b16 v[102:103], v14 offset:8544
    ds_read_b64_tr_b16 v[104:105], v13 offset:8576
    ds_read_b64_tr_b16 v[106:107], v14 offset:8608
    ds_read_b64_tr_b16 v[108:109], v13 offset:8640
    ds_read_b64_tr_b16 v[110:111], v14 offset:8672
    ds_read_b64_tr_b16 v[112:113], v13 offset:8704
    ds_read_b64_tr_b16 v[114:115], v14 offset:8736
    ds_read_b64_tr_b16 v[116:117], v13 offset:8768
    ds_read_b64_tr_b16 v[118:119], v14 offset:8800
    ds_read_b64_tr_b16 v[120:121], v13 offset:8832
    ds_read_b64_tr_b16 v[122:123], v14 offset:8864
    ds_read_b64_tr_b16 v[124:125], v13 offset:8896
    ds_read_b64_tr_b16 v[126:127], v14 offset:8928
    s_waitcnt lgkmcnt(12)
    v_mfma_f32_16x16x16_bf16 v[32:35], v[194:195], v[96:97], v[32:35]
    v_mfma_f32_16x16x16_bf16 v[36:39], v[194:195], v[98:99], v[36:39]
    v_mfma_f32_16x16x16_bf16 v[40:43], v[194:195], v[100:101], v[40:43]
    v_mfma_f32_16x16x16_bf16 v[44:47], v[194:195], v[102:103], v[44:47]
    s_waitcnt lgkmcnt(8)
    v_mfma_f32_16x16x16_bf16 v[48:51], v[194:195], v[104:105], v[48:51]
    v_mfma_f32_16x16x16_bf16 v[52:55], v[194:195], v[106:107], v[52:55]
    v_mfma_f32_16x16x16_bf16 v[56:59], v[194:195], v[108:109], v[56:59]
    v_mfma_f32_16x16x16_bf16 v[60:63], v[194:195], v[110:111], v[60:63]
    s_waitcnt lgkmcnt(4)
    v_mfma_f32_16x16x16_bf16 v[64:67], v[194:195], v[112:113], v[64:67]
    v_mfma_f32_16x16x16_bf16 v[68:71], v[194:195], v[114:115], v[68:71]
    v_mfma_f32_16x16x16_bf16 v[72:75], v[194:195], v[116:117], v[72:75]
    v_mfma_f32_16x16x16_bf16 v[76:79], v[194:195], v[118:119], v[76:79]
    s_waitcnt lgkmcnt(0)
    v_mfma_f32_16x16x16_bf16 v[80:83], v[194:195], v[120:121], v[80:83]
    v_mfma_f32_16x16x16_bf16 v[84:87], v[194:195], v[122:123], v[84:87]
    v_mfma_f32_16x16x16_bf16 v[88:91], v[194:195], v[124:125], v[88:91]
    v_mfma_f32_16x16x16_bf16 v[92:95], v[194:195], v[126:127], v[92:95]
    s_waitcnt vmcnt(17)
    buffer_load_dwordx4 a[36:39], v2, s[12:15], s101 offen offset:256 nt
    s_add_u32 m0, s61, 28512
    s_add_u32 s60, s63, 161280
    buffer_load_dwordx4 v6, s[24:27], s60 offen lds
    s_waitcnt vmcnt(17)
    buffer_load_dwordx4 a[40:43], v2, s[12:15], s101 offen offset:2048 nt
    s_waitcnt vmcnt(17)
    buffer_load_dwordx4 a[44:47], v2, s[12:15], s101 offen offset:2304 nt
    s_add_u32 m0, s61, 29568
    s_add_u32 s60, s63, 172032
    buffer_load_dwordx4 v6, s[24:27], s60 offen lds
    ds_read_b64_tr_b16 v[96:97], v13 offset:16896
    ds_read_b64_tr_b16 v[98:99], v14 offset:16928
    ds_read_b64_tr_b16 v[100:101], v13 offset:16960
    ds_read_b64_tr_b16 v[102:103], v14 offset:16992
    ds_read_b64_tr_b16 v[104:105], v13 offset:17024
    ds_read_b64_tr_b16 v[106:107], v14 offset:17056
    ds_read_b64_tr_b16 v[108:109], v13 offset:17088
    ds_read_b64_tr_b16 v[110:111], v14 offset:17120
    ds_read_b64_tr_b16 v[112:113], v13 offset:17152
    ds_read_b64_tr_b16 v[114:115], v14 offset:17184
    ds_read_b64_tr_b16 v[116:117], v13 offset:17216
    ds_read_b64_tr_b16 v[118:119], v14 offset:17248
    ds_read_b64_tr_b16 v[120:121], v13 offset:17280
    ds_read_b64_tr_b16 v[122:123], v14 offset:17312
    ds_read_b64_tr_b16 v[124:125], v13 offset:17344
    ds_read_b64_tr_b16 v[126:127], v14 offset:17376
    s_waitcnt lgkmcnt(12)
    v_mfma_f32_16x16x16_bf16 v[32:35], v[196:197], v[96:97], v[32:35]
    v_mfma_f32_16x16x16_bf16 v[36:39], v[196:197], v[98:99], v[36:39]
    v_mfma_f32_16x16x16_bf16 v[40:43], v[196:197], v[100:101], v[40:43]
    v_mfma_f32_16x16x16_bf16 v[44:47], v[196:197], v[102:103], v[44:47]
    s_waitcnt lgkmcnt(8)
    v_mfma_f32_16x16x16_bf16 v[48:51], v[196:197], v[104:105], v[48:51]
    v_mfma_f32_16x16x16_bf16 v[52:55], v[196:197], v[106:107], v[52:55]
    v_mfma_f32_16x16x16_bf16 v[56:59], v[196:197], v[108:109], v[56:59]
    v_mfma_f32_16x16x16_bf16 v[60:63], v[196:197], v[110:111], v[60:63]
    s_waitcnt lgkmcnt(4)
    v_mfma_f32_16x16x16_bf16 v[64:67], v[196:197], v[112:113], v[64:67]
    v_mfma_f32_16x16x16_bf16 v[68:71], v[196:197], v[114:115], v[68:71]
    v_mfma_f32_16x16x16_bf16 v[72:75], v[196:197], v[116:117], v[72:75]
    v_mfma_f32_16x16x16_bf16 v[76:79], v[196:197], v[118:119], v[76:79]
    s_waitcnt lgkmcnt(0)
    v_mfma_f32_16x16x16_bf16 v[80:83], v[196:197], v[120:121], v[80:83]
    v_mfma_f32_16x16x16_bf16 v[84:87], v[196:197], v[122:123], v[84:87]
    v_mfma_f32_16x16x16_bf16 v[88:91], v[196:197], v[124:125], v[88:91]
    v_mfma_f32_16x16x16_bf16 v[92:95], v[196:197], v[126:127], v[92:95]
    s_waitcnt vmcnt(17)
    s_add_u32 s101, s7, 442368
    buffer_load_dwordx4 a[48:51], v2, s[12:15], s101 offen offset:0 nt
    s_waitcnt vmcnt(17)
    buffer_load_dwordx4 a[52:55], v2, s[12:15], s101 offen offset:256 nt
    s_add_u32 m0, s61, 30624
    s_add_u32 s60, s63, 186368
    buffer_load_dwordx4 v6, s[24:27], s60 offen lds
    s_waitcnt vmcnt(17)
    buffer_load_dwordx4 a[56:59], v2, s[12:15], s101 offen offset:2048 nt
    s_add_u32 m0, s61, 31680
    s_add_u32 s60, s63, 200704
    buffer_load_dwordx4 v6, s[24:27], s60 offen lds
    ds_read_b64_tr_b16 a[162:163], v11 offset:33792
    ds_read_b64_tr_b16 a[166:167], v11 offset:33824
    ds_read_b64_tr_b16 a[170:171], v11 offset:33856
    ds_read_b64_tr_b16 a[174:175], v11 offset:33888
    ds_read_b64_tr_b16 a[178:179], v12 offset:33920
    ds_read_b64_tr_b16 a[182:183], v12 offset:33952
    ds_read_b64_tr_b16 a[186:187], v12 offset:33984
    ds_read_b64_tr_b16 a[190:191], v12 offset:34016
    s_waitcnt lgkmcnt(0)
    s_waitcnt vmcnt(18)
    buffer_load_dwordx4 a[60:63], v2, s[12:15], s101 offen offset:2304 nt
    s_waitcnt vmcnt(17)
    s_add_u32 s101, s7, 458752
    buffer_load_dwordx4 a[64:67], v2, s[12:15], s101 offen offset:0 nt
    s_add_u32 m0, s61, 32736
    s_add_u32 s60, s63, 215040
    buffer_load_dwordx4 v6, s[24:27], s60 offen lds
    s_waitcnt vmcnt(18)
    buffer_load_dwordx4 a[68:71], v2, s[12:15], s101 offen offset:256 nt
    s_waitcnt vmcnt(17)
    buffer_load_dwordx4 a[72:75], v2, s[12:15], s101 offen offset:2048 nt
    s_add_u32 m0, s61, 33792
    s_add_u32 s60, s63, 114688
    buffer_load_dwordx4 v6, s[24:27], s60 offen lds
    s_waitcnt vmcnt(18)
    buffer_load_dwordx4 a[76:79], v2, s[12:15], s101 offen offset:2304 nt
    v_mfma_f32_16x16x32_bf16 v[224:227], a[0:3], v[160:163], 0
    v_mfma_f32_16x16x32_bf16 v[228:231], a[8:11], v[160:163], 0
    v_mfma_f32_16x16x32_bf16 v[232:235], a[16:19], v[160:163], 0
    v_mfma_f32_16x16x32_bf16 v[236:239], a[24:27], v[160:163], 0
    v_mfma_f32_16x16x32_bf16 v[224:227], a[4:7], v[164:167], v[224:227]
    v_mfma_f32_16x16x32_bf16 v[228:231], a[12:15], v[164:167], v[228:231]
    v_mfma_f32_16x16x32_bf16 v[232:235], a[20:23], v[164:167], v[232:235]
    v_mfma_f32_16x16x32_bf16 v[236:239], a[28:31], v[164:167], v[236:239]
    s_nop 4
    v_mov_b32_dpp v168, v224 quad_perm:[0,0,0,0] row_mask:0xf bank_mask:0xf
    v_mov_b32_dpp v169, v228 quad_perm:[0,0,0,0] row_mask:0xf bank_mask:0xf
    v_mov_b32_dpp v170, v232 quad_perm:[0,0,0,0] row_mask:0xf bank_mask:0xf
    v_mov_b32_dpp v171, v236 quad_perm:[0,0,0,0] row_mask:0xf bank_mask:0xf
    v_add_f32_dpp v168, v225, v168 quad_perm:[1,1,1,1] row_mask:0xf bank_mask:0xf
    v_add_f32_dpp v169, v229, v169 quad_perm:[1,1,1,1] row_mask:0xf bank_mask:0xf
    v_add_f32_dpp v170, v233, v170 quad_perm:[1,1,1,1] row_mask:0xf bank_mask:0xf
    v_add_f32_dpp v171, v237, v171 quad_perm:[1,1,1,1] row_mask:0xf bank_mask:0xf
    v_add_f32_dpp v168, v226, v168 quad_perm:[2,2,2,2] row_mask:0xf bank_mask:0xf
    v_add_f32_dpp v169, v230, v169 quad_perm:[2,2,2,2] row_mask:0xf bank_mask:0xf
    v_add_f32_dpp v170, v234, v170 quad_perm:[2,2,2,2] row_mask:0xf bank_mask:0xf
    v_add_f32_dpp v171, v238, v171 quad_perm:[2,2,2,2] row_mask:0xf bank_mask:0xf
    v_add_f32_dpp v168, v227, v168 quad_perm:[3,3,3,3] row_mask:0xf bank_mask:0xf
    v_add_f32_dpp v169, v231, v169 quad_perm:[3,3,3,3] row_mask:0xf bank_mask:0xf
    v_add_f32_dpp v170, v235, v170 quad_perm:[3,3,3,3] row_mask:0xf bank_mask:0xf
    v_add_f32_dpp v171, v239, v171 quad_perm:[3,3,3,3] row_mask:0xf bank_mask:0xf
    v_max3_f32 v0, v168, v169, v0
    v_max3_f32 v0, v170, v171, v0
    v_cvt_pk_bf16_f32 v216, v168, v169
    v_cvt_pk_bf16_f32 v217, v170, v171
    s_waitcnt vmcnt(17)
    s_add_u32 s101, s7, 475136
    buffer_load_dwordx4 a[80:83], v2, s[12:15], s101 offen offset:0 nt
    s_add_u32 m0, s61, 34848
    s_add_u32 s60, s63, 129024
    buffer_load_dwordx4 v6, s[24:27], s60 offen lds
    s_waitcnt vmcnt(18)
    buffer_load_dwordx4 a[84:87], v2, s[12:15], s101 offen offset:256 nt
    s_waitcnt vmcnt(17)
    buffer_load_dwordx4 a[88:91], v2, s[12:15], s101 offen offset:2048 nt
    s_add_u32 m0, s61, 35904
    s_add_u32 s60, s63, 143360
    buffer_load_dwordx4 v6, s[24:27], s60 offen lds
    ds_read_b64_tr_b16 a[160:161], v11 offset:25344
    ds_read_b64_tr_b16 a[164:165], v11 offset:25376
    ds_read_b64_tr_b16 a[168:169], v11 offset:25408
    ds_read_b64_tr_b16 a[172:173], v11 offset:25440
    ds_read_b64_tr_b16 a[176:177], v12 offset:25472
    ds_read_b64_tr_b16 a[180:181], v12 offset:25504
    ds_read_b64_tr_b16 a[184:185], v12 offset:25536
    ds_read_b64_tr_b16 a[188:189], v12 offset:25568
    s_waitcnt lgkmcnt(0)
    s_waitcnt vmcnt(18)
    buffer_load_dwordx4 a[92:95], v2, s[12:15], s101 offen offset:2304 nt
    s_waitcnt vmcnt(17)
    s_add_u32 s101, s7, 491520
    buffer_load_dwordx4 a[96:99], v2, s[12:15], s101 offen offset:0 nt
    s_add_u32 m0, s61, 36960
    s_add_u32 s60, s63, 157696
    buffer_load_dwordx4 v6, s[24:27], s60 offen lds
    s_waitcnt vmcnt(18)
    buffer_load_dwordx4 a[100:103], v2, s[12:15], s101 offen offset:256 nt
    s_waitcnt vmcnt(17)
    buffer_load_dwordx4 a[104:107], v2, s[12:15], s101 offen offset:2048 nt
    s_add_u32 m0, s61, 25344
    s_add_u32 s60, s89, 0
    buffer_load_dwordx4 v6, s[32:35], s60 offen lds
    s_waitcnt vmcnt(17)
    buffer_load_dwordx4 a[108:111], v2, s[12:15], s101 offen offset:2304 nt
    v_mfma_f32_16x16x32_bf16 v[224:227], a[32:35], v[160:163], 0
    v_mfma_f32_16x16x32_bf16 v[228:231], a[40:43], v[160:163], 0
    v_mfma_f32_16x16x32_bf16 v[232:235], a[48:51], v[160:163], 0
    v_mfma_f32_16x16x32_bf16 v[236:239], a[56:59], v[160:163], 0
    v_mfma_f32_16x16x32_bf16 v[224:227], a[36:39], v[164:167], v[224:227]
    v_mfma_f32_16x16x32_bf16 v[228:231], a[44:47], v[164:167], v[228:231]
    v_mfma_f32_16x16x32_bf16 v[232:235], a[52:55], v[164:167], v[232:235]
    v_mfma_f32_16x16x32_bf16 v[236:239], a[60:63], v[164:167], v[236:239]
    s_nop 4
    v_mov_b32_dpp v168, v224 quad_perm:[0,0,0,0] row_mask:0xf bank_mask:0xf
    v_mov_b32_dpp v169, v228 quad_perm:[0,0,0,0] row_mask:0xf bank_mask:0xf
    v_mov_b32_dpp v170, v232 quad_perm:[0,0,0,0] row_mask:0xf bank_mask:0xf
    v_mov_b32_dpp v171, v236 quad_perm:[0,0,0,0] row_mask:0xf bank_mask:0xf
    v_add_f32_dpp v168, v225, v168 quad_perm:[1,1,1,1] row_mask:0xf bank_mask:0xf
    v_add_f32_dpp v169, v229, v169 quad_perm:[1,1,1,1] row_mask:0xf bank_mask:0xf
    v_add_f32_dpp v170, v233, v170 quad_perm:[1,1,1,1] row_mask:0xf bank_mask:0xf
    v_add_f32_dpp v171, v237, v171 quad_perm:[1,1,1,1] row_mask:0xf bank_mask:0xf
    v_add_f32_dpp v168, v226, v168 quad_perm:[2,2,2,2] row_mask:0xf bank_mask:0xf
    v_add_f32_dpp v169, v230, v169 quad_perm:[2,2,2,2] row_mask:0xf bank_mask:0xf
    v_add_f32_dpp v170, v234, v170 quad_perm:[2,2,2,2] row_mask:0xf bank_mask:0xf
    v_add_f32_dpp v171, v238, v171 quad_perm:[2,2,2,2] row_mask:0xf bank_mask:0xf
    v_add_f32_dpp v168, v227, v168 quad_perm:[3,3,3,3] row_mask:0xf bank_mask:0xf
    v_add_f32_dpp v169, v231, v169 quad_perm:[3,3,3,3] row_mask:0xf bank_mask:0xf
    v_add_f32_dpp v170, v235, v170 quad_perm:[3,3,3,3] row_mask:0xf bank_mask:0xf
    v_add_f32_dpp v171, v239, v171 quad_perm:[3,3,3,3] row_mask:0xf bank_mask:0xf
    v_max3_f32 v0, v168, v169, v0
    v_max3_f32 v0, v170, v171, v0
    v_cvt_pk_bf16_f32 v218, v168, v169
    v_cvt_pk_bf16_f32 v219, v170, v171
    s_waitcnt vmcnt(17)
    s_add_u32 s101, s7, 507904
    buffer_load_dwordx4 a[112:115], v2, s[12:15], s101 offen offset:0 nt
    s_add_u32 m0, s61, 26400
    s_add_u32 s60, s89, 3584
    buffer_load_dwordx4 v6, s[32:35], s60 offen lds
    s_waitcnt vmcnt(17)
    buffer_load_dwordx4 a[116:119], v2, s[12:15], s101 offen offset:256 nt
    ds_read_b64_tr_b16 a[130:131], v11 offset:29568
    ds_read_b64_tr_b16 a[134:135], v11 offset:29600
    ds_read_b64_tr_b16 a[138:139], v11 offset:29632
    ds_read_b64_tr_b16 a[142:143], v11 offset:29664
    ds_read_b64_tr_b16 a[146:147], v12 offset:29696
    ds_read_b64_tr_b16 a[150:151], v12 offset:29728
    ds_read_b64_tr_b16 a[154:155], v12 offset:29760
    ds_read_b64_tr_b16 a[158:159], v12 offset:29792
    s_waitcnt lgkmcnt(0)
    s_waitcnt vmcnt(17)
    buffer_load_dwordx4 a[120:123], v2, s[12:15], s101 offen offset:2048 nt
    s_add_u32 m0, s61, 27456
    s_add_u32 s60, s89, 7168
    buffer_load_dwordx4 v6, s[32:35], s60 offen lds
    s_waitcnt vmcnt(17)
    buffer_load_dwordx4 a[124:127], v2, s[12:15], s101 offen offset:2304 nt
    s_waitcnt vmcnt(17)
    s_add_u32 m0, s61, 0
    s_add_u32 s60, s7, 98304
    buffer_load_dwordx4 v3, s[16:19], s60 offen nt lds
    s_add_u32 m0, s61, 28512
    s_add_u32 s60, s89, 10752
    buffer_load_dwordx4 v6, s[32:35], s60 offen lds
    s_lshl_b32 s100, s98, 12
    s_add_u32 s100, s100, 2097152
    buffer_load_dwordx4 v[240:243], v16, s[52:55], s100 offen offset:0 sc1
    buffer_load_dwordx4 v[244:247], v16, s[52:55], s100 offen offset:1024 sc1
    buffer_load_dwordx4 v[248:251], v16, s[52:55], s100 offen offset:2048 sc1
    buffer_load_dwordx4 v[252:255], v16, s[52:55], s100 offen offset:3072 sc1
    s_waitcnt vmcnt(21)
    s_add_u32 m0, s61, 1056
    s_add_u32 s60, s7, 99328
    buffer_load_dwordx4 v3, s[16:19], s60 offen nt lds
    s_waitcnt vmcnt(21)
    s_add_u32 m0, s61, 2112
    s_add_u32 s60, s7, 100352
    buffer_load_dwordx4 v3, s[16:19], s60 offen nt lds
    s_add_u32 m0, s61, 29568
    s_add_u32 s60, s89, 14336
    buffer_load_dwordx4 v6, s[32:35], s60 offen lds
    s_waitcnt vmcnt(21)
    s_add_u32 m0, s61, 3168
    s_add_u32 s60, s7, 101376
    buffer_load_dwordx4 v3, s[16:19], s60 offen nt lds
    v_mfma_f32_16x16x32_bf16 v[224:227], a[64:67], v[160:163], 0
    v_mfma_f32_16x16x32_bf16 v[228:231], a[72:75], v[160:163], 0
    v_mfma_f32_16x16x32_bf16 v[232:235], a[80:83], v[160:163], 0
    v_mfma_f32_16x16x32_bf16 v[236:239], a[88:91], v[160:163], 0
    v_mfma_f32_16x16x32_bf16 v[224:227], a[68:71], v[164:167], v[224:227]
    v_mfma_f32_16x16x32_bf16 v[228:231], a[76:79], v[164:167], v[228:231]
    v_mfma_f32_16x16x32_bf16 v[232:235], a[84:87], v[164:167], v[232:235]
    v_mfma_f32_16x16x32_bf16 v[236:239], a[92:95], v[164:167], v[236:239]
    s_nop 4
    v_mov_b32_dpp v168, v224 quad_perm:[0,0,0,0] row_mask:0xf bank_mask:0xf
    v_mov_b32_dpp v169, v228 quad_perm:[0,0,0,0] row_mask:0xf bank_mask:0xf
    v_mov_b32_dpp v170, v232 quad_perm:[0,0,0,0] row_mask:0xf bank_mask:0xf
    v_mov_b32_dpp v171, v236 quad_perm:[0,0,0,0] row_mask:0xf bank_mask:0xf
    v_add_f32_dpp v168, v225, v168 quad_perm:[1,1,1,1] row_mask:0xf bank_mask:0xf
    v_add_f32_dpp v169, v229, v169 quad_perm:[1,1,1,1] row_mask:0xf bank_mask:0xf
    v_add_f32_dpp v170, v233, v170 quad_perm:[1,1,1,1] row_mask:0xf bank_mask:0xf
    v_add_f32_dpp v171, v237, v171 quad_perm:[1,1,1,1] row_mask:0xf bank_mask:0xf
    v_add_f32_dpp v168, v226, v168 quad_perm:[2,2,2,2] row_mask:0xf bank_mask:0xf
    v_add_f32_dpp v169, v230, v169 quad_perm:[2,2,2,2] row_mask:0xf bank_mask:0xf
    v_add_f32_dpp v170, v234, v170 quad_perm:[2,2,2,2] row_mask:0xf bank_mask:0xf
    v_add_f32_dpp v171, v238, v171 quad_perm:[2,2,2,2] row_mask:0xf bank_mask:0xf
    v_add_f32_dpp v168, v227, v168 quad_perm:[3,3,3,3] row_mask:0xf bank_mask:0xf
    v_add_f32_dpp v169, v231, v169 quad_perm:[3,3,3,3] row_mask:0xf bank_mask:0xf
    v_add_f32_dpp v170, v235, v170 quad_perm:[3,3,3,3] row_mask:0xf bank_mask:0xf
    v_add_f32_dpp v171, v239, v171 quad_perm:[3,3,3,3] row_mask:0xf bank_mask:0xf
    v_max3_f32 v0, v168, v169, v0
    v_max3_f32 v0, v170, v171, v0
    v_cvt_pk_bf16_f32 v220, v168, v169
    v_cvt_pk_bf16_f32 v221, v170, v171
    s_waitcnt vmcnt(21)
    s_add_u32 m0, s61, 4224
    s_add_u32 s60, s7, 114688
    buffer_load_dwordx4 v3, s[16:19], s60 offen nt lds
    s_add_u32 m0, s61, 30624
    s_add_u32 s60, s89, 17920
    buffer_load_dwordx4 v6, s[32:35], s60 offen lds
    s_waitcnt vmcnt(21)
    s_add_u32 m0, s61, 5280
    s_add_u32 s60, s7, 115712
    buffer_load_dwordx4 v3, s[16:19], s60 offen nt lds
    s_add_u32 m0, s61, 31680
    s_add_u32 s60, s89, 21504
    buffer_load_dwordx4 v6, s[32:35], s60 offen lds
    ds_read_b64_tr_b16 a[128:129], v11 offset:33792
    ds_read_b64_tr_b16 a[132:133], v11 offset:33824
    ds_read_b64_tr_b16 a[136:137], v11 offset:33856
    ds_read_b64_tr_b16 a[140:141], v11 offset:33888
    ds_read_b64_tr_b16 a[144:145], v12 offset:33920
    ds_read_b64_tr_b16 a[148:149], v12 offset:33952
    ds_read_b64_tr_b16 a[152:153], v12 offset:33984
    ds_read_b64_tr_b16 a[156:157], v12 offset:34016
    s_waitcnt lgkmcnt(0)
    s_waitcnt vmcnt(22)
    s_add_u32 m0, s61, 6336
    s_add_u32 s60, s7, 116736
    buffer_load_dwordx4 v3, s[16:19], s60 offen nt lds
    s_waitcnt vmcnt(21)
    s_add_u32 m0, s61, 7392
    s_add_u32 s60, s7, 117760
    buffer_load_dwordx4 v3, s[16:19], s60 offen nt lds
    s_add_u32 m0, s61, 32736
    s_add_u32 s60, s89, 25088
    buffer_load_dwordx4 v6, s[32:35], s60 offen lds
    s_waitcnt vmcnt(22)
    s_add_u32 m0, s61, 8448
    s_add_u32 s60, s7, 131072
    buffer_load_dwordx4 v3, s[16:19], s60 offen nt lds
    s_waitcnt vmcnt(21)
    s_add_u32 m0, s61, 9504
    s_add_u32 s60, s7, 132096
    buffer_load_dwordx4 v3, s[16:19], s60 offen nt lds
    s_add_u32 m0, s61, 33792
    s_add_u32 s60, s63, 68096
    buffer_load_dwordx4 v6, s[24:27], s60 offen lds
    s_waitcnt vmcnt(22)
    s_add_u32 m0, s61, 10560
    s_add_u32 s60, s7, 133120
    buffer_load_dwordx4 v3, s[16:19], s60 offen nt lds
    s_waitcnt vmcnt(21)
    s_add_u32 m0, s61, 11616
    s_add_u32 s60, s7, 134144
    buffer_load_dwordx4 v3, s[16:19], s60 offen nt lds
    s_add_u32 m0, s61, 34848
    s_add_u32 s60, s63, 82432
    buffer_load_dwordx4 v6, s[24:27], s60 offen lds
    v_mfma_f32_16x16x32_bf16 v[224:227], a[96:99], v[160:163], 0
    v_mfma_f32_16x16x32_bf16 v[228:231], a[104:107], v[160:163], 0
    v_mfma_f32_16x16x32_bf16 v[232:235], a[112:115], v[160:163], 0
    v_mfma_f32_16x16x32_bf16 v[236:239], a[120:123], v[160:163], 0
    v_mfma_f32_16x16x32_bf16 v[224:227], a[100:103], v[164:167], v[224:227]
    v_mfma_f32_16x16x32_bf16 v[228:231], a[108:111], v[164:167], v[228:231]
    v_mfma_f32_16x16x32_bf16 v[232:235], a[116:119], v[164:167], v[232:235]
    v_mfma_f32_16x16x32_bf16 v[236:239], a[124:127], v[164:167], v[236:239]
    s_nop 4
    v_mov_b32_dpp v168, v224 quad_perm:[0,0,0,0] row_mask:0xf bank_mask:0xf
    v_mov_b32_dpp v169, v228 quad_perm:[0,0,0,0] row_mask:0xf bank_mask:0xf
    v_mov_b32_dpp v170, v232 quad_perm:[0,0,0,0] row_mask:0xf bank_mask:0xf
    v_mov_b32_dpp v171, v236 quad_perm:[0,0,0,0] row_mask:0xf bank_mask:0xf
    v_add_f32_dpp v168, v225, v168 quad_perm:[1,1,1,1] row_mask:0xf bank_mask:0xf
    v_add_f32_dpp v169, v229, v169 quad_perm:[1,1,1,1] row_mask:0xf bank_mask:0xf
    v_add_f32_dpp v170, v233, v170 quad_perm:[1,1,1,1] row_mask:0xf bank_mask:0xf
    v_add_f32_dpp v171, v237, v171 quad_perm:[1,1,1,1] row_mask:0xf bank_mask:0xf
    v_add_f32_dpp v168, v226, v168 quad_perm:[2,2,2,2] row_mask:0xf bank_mask:0xf
    v_add_f32_dpp v169, v230, v169 quad_perm:[2,2,2,2] row_mask:0xf bank_mask:0xf
    v_add_f32_dpp v170, v234, v170 quad_perm:[2,2,2,2] row_mask:0xf bank_mask:0xf
    v_add_f32_dpp v171, v238, v171 quad_perm:[2,2,2,2] row_mask:0xf bank_mask:0xf
    v_add_f32_dpp v168, v227, v168 quad_perm:[3,3,3,3] row_mask:0xf bank_mask:0xf
    v_add_f32_dpp v169, v231, v169 quad_perm:[3,3,3,3] row_mask:0xf bank_mask:0xf
    v_add_f32_dpp v170, v235, v170 quad_perm:[3,3,3,3] row_mask:0xf bank_mask:0xf
    v_add_f32_dpp v171, v239, v171 quad_perm:[3,3,3,3] row_mask:0xf bank_mask:0xf
    v_max3_f32 v0, v168, v169, v0
    v_max3_f32 v0, v170, v171, v0
    v_cvt_pk_bf16_f32 v222, v168, v169
    v_cvt_pk_bf16_f32 v223, v170, v171
    s_waitcnt vmcnt(22)
    s_add_u32 m0, s61, 12672
    s_add_u32 s60, s7, 147456
    buffer_load_dwordx4 v3, s[16:19], s60 offen nt lds
    v_mov_b32 v22, v0
    s_nop 1
    v_permlane16_swap_b32 v22, v0
    v_max_f32 v0, v0, v22
    v_mov_b32 v22, v0
    s_nop 1
    v_permlane32_swap_b32 v22, v0
    v_max_f32 v0, v0, v22
    v_cvt_pk_bf16_f32 v0, v0, v0
    v_and_b32 v0, 0xffff0000, v0
    v_mul_f32 v0, s94, v0
    v_max_f32 v0, v0, v18
    v_sub_f32 v22, v18, v0
    v_exp_f32 v22, v22
    v_add_f32 v21, v20, v21
    v_mul_f32 v21, v21, v22
    v_lshlrev_b32 v224, 16, v216
    v_and_b32 v225, 0xffff0000, v216
    v_fma_f32 v224, v224, s94, -v0
    v_fma_f32 v225, v225, s94, -v0
    v_exp_f32 v224, v224
    v_exp_f32 v225, v225
    v_lshlrev_b32 v226, 16, v217
    v_and_b32 v227, 0xffff0000, v217
    v_fma_f32 v226, v226, s94, -v0
    v_fma_f32 v227, v227, s94, -v0
    v_exp_f32 v226, v226
    v_exp_f32 v227, v227
    v_lshlrev_b32 v228, 16, v218
    v_and_b32 v229, 0xffff0000, v218
    v_fma_f32 v228, v228, s94, -v0
    v_fma_f32 v229, v229, s94, -v0
    v_exp_f32 v228, v228
    v_exp_f32 v229, v229
    v_lshlrev_b32 v230, 16, v219
    v_and_b32 v231, 0xffff0000, v219
    v_fma_f32 v230, v230, s94, -v0
    v_fma_f32 v231, v231, s94, -v0
    v_exp_f32 v230, v230
    v_exp_f32 v231, v231
    v_lshlrev_b32 v232, 16, v220
    v_and_b32 v233, 0xffff0000, v220
    v_fma_f32 v232, v232, s94, -v0
    v_fma_f32 v233, v233, s94, -v0
    v_exp_f32 v232, v232
    v_exp_f32 v233, v233
    v_lshlrev_b32 v234, 16, v221
    v_and_b32 v235, 0xffff0000, v221
    v_fma_f32 v234, v234, s94, -v0
    v_fma_f32 v235, v235, s94, -v0
    v_exp_f32 v234, v234
    v_exp_f32 v235, v235
    v_lshlrev_b32 v236, 16, v222
    v_and_b32 v237, 0xffff0000, v222
    v_fma_f32 v236, v236, s94, -v0
    v_fma_f32 v237, v237, s94, -v0
    v_exp_f32 v236, v236
    v_exp_f32 v237, v237
    v_lshlrev_b32 v238, 16, v223
    v_and_b32 v239, 0xffff0000, v223
    v_fma_f32 v238, v238, s94, -v0
    v_fma_f32 v239, v239, s94, -v0
    v_exp_f32 v238, v238
    v_exp_f32 v239, v239
    v_mov_b32 v20, 0
    v_pk_add_f32 v[20:21], v[20:21], v[224:225]
    v_pk_add_f32 v[20:21], v[20:21], v[226:227]
    v_pk_add_f32 v[20:21], v[20:21], v[228:229]
    v_pk_add_f32 v[20:21], v[20:21], v[230:231]
    v_pk_add_f32 v[20:21], v[20:21], v[232:233]
    v_pk_add_f32 v[20:21], v[20:21], v[234:235]
    v_pk_add_f32 v[20:21], v[20:21], v[236:237]
    v_pk_add_f32 v[20:21], v[20:21], v[238:239]
    v_add_f32 v21, v20, v21
    v_mov_b32 v22, v21
    s_nop 1
    v_permlane16_swap_b32 v22, v21
    v_add_f32 v21, v21, v22
    v_mov_b32 v22, v21
    s_nop 1
    v_permlane32_swap_b32 v22, v21
    v_add_f32 v21, v21, v22
    v_mov_b32 v20, v0
    s_lshl_b32 s90, s3, 3
    v_mov_b32 v22, s90
    s_mov_b64 exec, 1
    ds_write_b64 v22, v[20:21] offset:4352
    s_mov_b64 exec, -1
    v_mov_b32 v22, 0
    s_waitcnt lgkmcnt(0)
    s_barrier
    ds_read_b128 v[160:163], v22 offset:4352
    ds_read_b128 v[164:167], v22 offset:4368
    s_waitcnt lgkmcnt(0)
    v_max3_f32 v20, v160, v162, v164
    v_max_f32 v20, v20, v166
    v_sub_f32 v22, v0, v20
    v_exp_f32 v22, v22
    v_sub_f32 v18, v18, v20
    v_exp_f32 v18, v18
    v_sub_f32 v160, v160, v20
    v_exp_f32 v160, v160
    v_sub_f32 v162, v162, v20
    v_exp_f32 v162, v162
    v_sub_f32 v164, v164, v20
    v_exp_f32 v164, v164
    v_sub_f32 v166, v166, v20
    v_exp_f32 v166, v166
    v_mov_b32 v23, v22
    v_readfirstlane_b32 s6, v18
    v_mul_f32 v21, v160, v161
    v_fmac_f32 v21, v162, v163
    v_fmac_f32 v21, v164, v165
    v_fmac_f32 v21, v166, v167
    v_pk_mul_f32 v[224:225], v[224:225], v[22:23]
    v_cvt_pk_bf16_f32 v216, v224, v225
    v_pk_mul_f32 v[226:227], v[226:227], v[22:23]
    v_cvt_pk_bf16_f32 v217, v226, v227
    v_pk_mul_f32 v[228:229], v[228:229], v[22:23]
    v_cvt_pk_bf16_f32 v218, v228, v229
    v_pk_mul_f32 v[230:231], v[230:231], v[22:23]
    v_cvt_pk_bf16_f32 v219, v230, v231
    v_pk_mul_f32 v[232:233], v[232:233], v[22:23]
    v_cvt_pk_bf16_f32 v220, v232, v233
    v_pk_mul_f32 v[234:235], v[234:235], v[22:23]
    v_cvt_pk_bf16_f32 v221, v234, v235
    v_pk_mul_f32 v[236:237], v[236:237], v[22:23]
    v_cvt_pk_bf16_f32 v222, v236, v237
    v_pk_mul_f32 v[238:239], v[238:239], v[22:23]
    v_cvt_pk_bf16_f32 v223, v238, v239
    s_lshr_b32 s90, s7, 19
    s_lshl_b32 s90, s90, 3
    s_add_u32 s90, s90, 1572864
    s_lshl_b32 s91, s3, 28
    s_add_u32 s90, s90, s91
    s_mov_b64 exec, 1
    buffer_store_dwordx2 v[20:21], off, s[44:47], s90 sc1
    s_mov_b64 exec, -1
    s_waitcnt vmcnt(18)
    s_add_u32 m0, s61, 13728
    s_add_u32 s60, s7, 148480
    buffer_load_dwordx4 v3, s[16:19], s60 offen nt lds
    s_add_u32 m0, s61, 35904
    s_add_u32 s60, s63, 96768
    buffer_load_dwordx4 v6, s[24:27], s60 offen lds
    s_mov_b32 s93, 262144
L_gg:
    v_pk_add_f32 v[240:241], v[240:241], v[244:245]
    v_pk_add_f32 v[248:249], v[248:249], v[252:253]
    v_pk_add_f32 v[242:243], v[242:243], v[246:247]
    v_pk_add_f32 v[250:251], v[250:251], v[254:255]
    v_permlane32_swap_b32 v240, v248
    v_permlane32_swap_b32 v241, v249
    v_permlane32_swap_b32 v242, v250
    v_permlane32_swap_b32 v243, v251
    v_pk_add_f32 v[240:241], v[240:241], v[248:249]
    v_pk_add_f32 v[242:243], v[242:243], v[250:251]
    v_add_f32 v22, v240, v241
    v_add_f32 v23, v242, v243
    v_cmp_u_f32 vcc, v22, v23
    s_nop 0
    s_cmp_eq_u64 vcc, 0
    s_cbranch_scc1 L_gg_ok
    s_sub_u32 s93, s93, 1
    s_cbranch_scc1 L_gg_ok
    buffer_load_dwordx4 v[240:243], v16, s[52:55], s100 offen offset:0 sc1
    buffer_load_dwordx4 v[244:247], v16, s[52:55], s100 offen offset:1024 sc1
    buffer_load_dwordx4 v[248:251], v16, s[52:55], s100 offen offset:2048 sc1
    buffer_load_dwordx4 v[252:255], v16, s[52:55], s100 offen offset:3072 sc1
    s_waitcnt vmcnt(0)
    s_branch L_gg
L_gg_ok:
    v_cvt_pk_bf16_f32 v240, v240, v240
    v_and_b32 v240, 0xffff0000, v240
    v_mov_b32 v244, v240
    v_cvt_pk_bf16_f32 v241, v241, v241
    v_and_b32 v241, 0xffff0000, v241
    v_mov_b32 v245, v241
    v_cvt_pk_bf16_f32 v242, v242, v242
    v_and_b32 v242, 0xffff0000, v242
    v_mov_b32 v246, v242
    v_cvt_pk_bf16_f32 v243, v243, v243
    v_and_b32 v243, 0xffff0000, v243
    v_mov_b32 v247, v243
    v_and_b32 v23, 3, v1
    v_lshlrev_b32 v22, 4, v23
    v_bfe_u32 v24, v1, 2, 3
    v_lshl_add_u32 v22, v24, 1, v22
    v_permlane32_swap_b32 v240, v244
    v_permlane32_swap_b32 v241, v245
    v_permlane32_swap_b32 v242, v246
    v_permlane32_swap_b32 v243, v247
    s_mul_i32 s90, s3, 768
    v_add_u32 v22, s90, v22
    v_mul_f32 v240, v240, v244
    v_mul_f32 v241, v241, v245
    v_mul_f32 v242, v242, v246
    v_mul_f32 v243, v243, v247
    v_mul_u32_u24 v23, 192, v23
    v_lshrrev_b32 v24, 4, v1
    v_lshl_add_u32 v23, v24, 4, v23
    v_add_u32 v23, s90, v23
    v_cvt_pk_bf16_f32 v240, v240, v241
    v_cvt_pk_bf16_f32 v241, v242, v243
    ds_write_b16 v22, v240 offset:0
    ds_write_b16_d16_hi v22, v240 offset:192
    ds_write_b16 v22, v241 offset:384
    ds_write_b16_d16_hi v22, v241 offset:576
    s_waitcnt lgkmcnt(0)
    ds_read_b128 v[24:27], v23 offset:0
    s_waitcnt lgkmcnt(0)
    s_waitcnt vmcnt(19)
    s_add_u32 m0, s61, 14784
    s_add_u32 s60, s7, 149504
    buffer_load_dwordx4 v3, s[16:19], s60 offen nt lds
    ds_read_b64_tr_b16 v[240:241], v11 offset:25344
    ds_read_b64_tr_b16 v[242:243], v11 offset:25376
    ds_read_b64_tr_b16 v[244:245], v11 offset:25408
    ds_read_b64_tr_b16 v[246:247], v11 offset:25440
    ds_read_b64_tr_b16 v[248:249], v12 offset:25472
    ds_read_b64_tr_b16 v[250:251], v12 offset:25504
    ds_read_b64_tr_b16 v[252:253], v12 offset:25536
    ds_read_b64_tr_b16 v[254:255], v12 offset:25568
    s_waitcnt lgkmcnt(0)
    v_mfma_f32_16x16x16_bf16 a[192:195], v[24:25], v[240:241], 0
    v_mfma_f32_16x16x16_bf16 a[196:199], v[24:25], v[242:243], 0
    v_mfma_f32_16x16x16_bf16 a[200:203], v[24:25], v[244:245], 0
    v_mfma_f32_16x16x16_bf16 a[204:207], v[24:25], v[246:247], 0
    v_mfma_f32_16x16x16_bf16 a[208:211], v[24:25], v[248:249], 0
    v_mfma_f32_16x16x16_bf16 a[212:215], v[24:25], v[250:251], 0
    v_mfma_f32_16x16x16_bf16 a[216:219], v[24:25], v[252:253], 0
    v_mfma_f32_16x16x16_bf16 a[220:223], v[24:25], v[254:255], 0
    s_waitcnt vmcnt(18)
    s_add_u32 m0, s61, 15840
    s_add_u32 s60, s7, 150528
    buffer_load_dwordx4 v3, s[16:19], s60 offen nt lds
    s_add_u32 m0, s61, 36960
    s_add_u32 s60, s63, 111104
    buffer_load_dwordx4 v6, s[24:27], s60 offen lds
    s_waitcnt vmcnt(19)
    s_add_u32 m0, s61, 16896
    s_add_u32 s60, s7, 163840
    buffer_load_dwordx4 v3, s[16:19], s60 offen nt lds
    s_waitcnt vmcnt(18)
    s_add_u32 m0, s61, 17952
    s_add_u32 s60, s7, 164864
    buffer_load_dwordx4 v3, s[16:19], s60 offen nt lds
    s_add_u32 m0, s61, 25344
    s_add_u32 s60, s63, 10752
    buffer_load_dwordx4 v6, s[24:27], s60 offen lds
    s_waitcnt vmcnt(18)
    s_add_u32 m0, s61, 19008
    s_add_u32 s60, s7, 165888
    buffer_load_dwordx4 v3, s[16:19], s60 offen nt lds
    s_waitcnt vmcnt(18)
    s_add_u32 m0, s61, 20064
    s_add_u32 s60, s7, 166912
    buffer_load_dwordx4 v3, s[16:19], s60 offen nt lds
    s_add_u32 m0, s61, 26400
    s_add_u32 s60, s63, 25088
    buffer_load_dwordx4 v6, s[24:27], s60 offen lds
    ds_read_b64_tr_b16 v[96:97], v13 offset:0
    ds_read_b64_tr_b16 v[98:99], v14 offset:32
    ds_read_b64_tr_b16 v[100:101], v13 offset:64
    ds_read_b64_tr_b16 v[102:103], v14 offset:96
    ds_read_b64_tr_b16 v[104:105], v13 offset:128
    ds_read_b64_tr_b16 v[106:107], v14 offset:160
    ds_read_b64_tr_b16 v[108:109], v13 offset:192
    ds_read_b64_tr_b16 v[110:111], v14 offset:224
    ds_read_b64_tr_b16 v[112:113], v13 offset:256
    ds_read_b64_tr_b16 v[114:115], v14 offset:288
    ds_read_b64_tr_b16 v[116:117], v13 offset:320
    ds_read_b64_tr_b16 v[118:119], v14 offset:352
    ds_read_b64_tr_b16 v[120:121], v13 offset:384
    ds_read_b64_tr_b16 v[122:123], v14 offset:416
    ds_read_b64_tr_b16 v[124:125], v13 offset:448
    ds_read_b64_tr_b16 v[126:127], v14 offset:480
    s_waitcnt lgkmcnt(12)
    v_mfma_f32_16x16x16_bf16 v[32:35], v[198:199], v[96:97], v[32:35]
    v_mfma_f32_16x16x16_bf16 v[36:39], v[198:199], v[98:99], v[36:39]
    v_mfma_f32_16x16x16_bf16 v[40:43], v[198:199], v[100:101], v[40:43]
    v_mfma_f32_16x16x16_bf16 v[44:47], v[198:199], v[102:103], v[44:47]
    s_waitcnt lgkmcnt(8)
    v_mfma_f32_16x16x16_bf16 v[48:51], v[198:199], v[104:105], v[48:51]
    v_mfma_f32_16x16x16_bf16 v[52:55], v[198:199], v[106:107], v[52:55]
    v_mfma_f32_16x16x16_bf16 v[56:59], v[198:199], v[108:109], v[56:59]
    v_mfma_f32_16x16x16_bf16 v[60:63], v[198:199], v[110:111], v[60:63]
    s_waitcnt lgkmcnt(4)
    v_mfma_f32_16x16x16_bf16 v[64:67], v[198:199], v[112:113], v[64:67]
    v_mfma_f32_16x16x16_bf16 v[68:71], v[198:199], v[114:115], v[68:71]
    v_mfma_f32_16x16x16_bf16 v[72:75], v[198:199], v[116:117], v[72:75]
    v_mfma_f32_16x16x16_bf16 v[76:79], v[198:199], v[118:119], v[76:79]
    s_waitcnt lgkmcnt(0)
    v_mfma_f32_16x16x16_bf16 v[80:83], v[198:199], v[120:121], v[80:83]
    v_mfma_f32_16x16x16_bf16 v[84:87], v[198:199], v[122:123], v[84:87]
    v_mfma_f32_16x16x16_bf16 v[88:91], v[198:199], v[124:125], v[88:91]
    v_mfma_f32_16x16x16_bf16 v[92:95], v[198:199], v[126:127], v[92:95]
    s_waitcnt vmcnt(18)
    s_add_u32 m0, s61, 21120
    s_add_u32 s60, s7, 180224
    buffer_load_dwordx4 v3, s[16:19], s60 offen nt lds
    ds_read_b64_tr_b16 v[240:241], v11 offset:29568
    ds_read_b64_tr_b16 v[242:243], v11 offset:29600
    ds_read_b64_tr_b16 v[244:245], v11 offset:29632
    ds_read_b64_tr_b16 v[246:247], v11 offset:29664
    ds_read_b64_tr_b16 v[248:249], v12 offset:29696
    ds_read_b64_tr_b16 v[250:251], v12 offset:29728
    ds_read_b64_tr_b16 v[252:253], v12 offset:29760
    ds_read_b64_tr_b16 v[254:255], v12 offset:29792
    s_waitcnt lgkmcnt(0)
    v_mfma_f32_16x16x16_bf16 a[192:195], v[26:27], v[240:241], a[192:195]
    v_mfma_f32_16x16x16_bf16 a[196:199], v[26:27], v[242:243], a[196:199]
    v_mfma_f32_16x16x16_bf16 a[200:203], v[26:27], v[244:245], a[200:203]
    v_mfma_f32_16x16x16_bf16 a[204:207], v[26:27], v[246:247], a[204:207]
    v_mfma_f32_16x16x16_bf16 a[208:211], v[26:27], v[248:249], a[208:211]
    v_mfma_f32_16x16x16_bf16 a[212:215], v[26:27], v[250:251], a[212:215]
    v_mfma_f32_16x16x16_bf16 a[216:219], v[26:27], v[252:253], a[216:219]
    v_mfma_f32_16x16x16_bf16 a[220:223], v[26:27], v[254:255], a[220:223]
    v_bfe_u32 v22, v1, 2, 2
    v_and_b32 v23, 3, v1
    v_lshlrev_b32 v23, 4, v23
    v_lshl_add_u32 v4, v22, 12, v23
    v_accvgpr_read_b32 v176, a192
    v_accvgpr_read_b32 v180, a193
    v_accvgpr_read_b32 v184, a194
    v_accvgpr_read_b32 v188, a195
    v_accvgpr_read_b32 v177, a196
    v_accvgpr_read_b32 v181, a197
    v_accvgpr_read_b32 v185, a198
    v_accvgpr_read_b32 v189, a199
    v_accvgpr_read_b32 v178, a200
    v_accvgpr_read_b32 v182, a201
    v_accvgpr_read_b32 v186, a202
    v_accvgpr_read_b32 v190, a203
    v_accvgpr_read_b32 v179, a204
    v_accvgpr_read_b32 v183, a205
    v_accvgpr_read_b32 v187, a206
    v_accvgpr_read_b32 v191, a207
    v_accvgpr_read_b32 v240, a208
    v_accvgpr_read_b32 v244, a209
    v_accvgpr_read_b32 v248, a210
    v_accvgpr_read_b32 v252, a211
    v_accvgpr_read_b32 v241, a212
    v_accvgpr_read_b32 v245, a213
    v_accvgpr_read_b32 v249, a214
    v_accvgpr_read_b32 v253, a215
    v_accvgpr_read_b32 v242, a216
    v_accvgpr_read_b32 v246, a217
    v_accvgpr_read_b32 v250, a218
    v_accvgpr_read_b32 v254, a219
    v_accvgpr_read_b32 v243, a220
    v_accvgpr_read_b32 v247, a221
    v_accvgpr_read_b32 v251, a222
    v_accvgpr_read_b32 v255, a223
    s_mov_b64 exec, 0xffff
    s_lshl_b32 s90, s3, 15
    s_lshl_b32 s91, s98, 6
    s_add_u32 s90, s90, s91
    s_add_u32 s90, s90, 524288
    buffer_store_dwordx4 v[176:179], v4, s[52:55], s90 offen sc1
    s_add_u32 s90, s90, 16384
    buffer_store_dwordx4 v[240:243], v4, s[52:55], s90 offen sc1
    s_lshl_b32 s90, s3, 15
    s_lshl_b32 s91, s98, 6
    s_add_u32 s90, s90, s91
    s_add_u32 s90, s90, 655360
    buffer_store_dwordx4 v[180:183], v4, s[52:55], s90 offen sc1
    s_add_u32 s90, s90, 16384
    buffer_store_dwordx4 v[244:247], v4, s[52:55], s90 offen sc1
    s_lshl_b32 s90, s3, 15
    s_lshl_b32 s91, s98, 6
    s_add_u32 s90, s90, s91
    s_add_u32 s90, s90, 786432
    buffer_store_dwordx4 v[184:187], v4, s[52:55], s90 offen sc1
    s_add_u32 s90, s90, 16384
    buffer_store_dwordx4 v[248:251], v4, s[52:55], s90 offen sc1
    s_lshl_b32 s90, s3, 15
    s_lshl_b32 s91, s98, 6
    s_add_u32 s90, s90, s91
    s_add_u32 s90, s90, 917504
    buffer_store_dwordx4 v[188:191], v4, s[52:55], s90 offen sc1
    s_add_u32 s90, s90, 16384
    buffer_store_dwordx4 v[252:255], v4, s[52:55], s90 offen sc1
    s_mov_b64 exec, -1
    s_waitcnt vmcnt(26)
    s_add_u32 m0, s61, 22176
    s_add_u32 s60, s7, 181248
    buffer_load_dwordx4 v3, s[16:19], s60 offen nt lds
    s_add_u32 m0, s61, 27456
    s_add_u32 s60, s63, 39424
    buffer_load_dwordx4 v6, s[24:27], s60 offen lds
    s_waitcnt vmcnt(26)
    s_add_u32 m0, s61, 23232
    s_add_u32 s60, s7, 182272
    buffer_load_dwordx4 v3, s[16:19], s60 offen nt lds
    s_waitcnt vmcnt(26)
    s_add_u32 m0, s61, 24288
    s_add_u32 s60, s7, 183296
    buffer_load_dwordx4 v3, s[16:19], s60 offen nt lds
    s_add_u32 m0, s61, 28512
    s_add_u32 s60, s63, 53760
    buffer_load_dwordx4 v6, s[24:27], s60 offen lds
    s_waitcnt vmcnt(26)
    s_add_u32 m0, s61, 0
    s_add_u32 s60, s7, 196608
    buffer_load_dwordx4 v3, s[16:19], s60 offen nt lds
    s_waitcnt vmcnt(25)
    s_add_u32 m0, s61, 1056
    s_add_u32 s60, s7, 197632
    buffer_load_dwordx4 v3, s[16:19], s60 offen nt lds
    s_add_u32 m0, s61, 29568
    s_add_u32 s60, s63, 64512
    buffer_load_dwordx4 v6, s[24:27], s60 offen lds
    s_waitcnt vmcnt(25)
    s_add_u32 m0, s61, 2112
    s_add_u32 s60, s7, 198656
    buffer_load_dwordx4 v3, s[16:19], s60 offen nt lds
    s_waitcnt vmcnt(25)
    s_add_u32 m0, s61, 3168
    s_add_u32 s60, s7, 199680
    buffer_load_dwordx4 v3, s[16:19], s60 offen nt lds
    s_add_u32 m0, s61, 30624
    s_add_u32 s60, s63, 78848
    buffer_load_dwordx4 v6, s[24:27], s60 offen lds
    ds_read_b64_tr_b16 v[96:97], v13 offset:8448
    ds_read_b64_tr_b16 v[98:99], v14 offset:8480
    ds_read_b64_tr_b16 v[100:101], v13 offset:8512
    ds_read_b64_tr_b16 v[102:103], v14 offset:8544
    ds_read_b64_tr_b16 v[104:105], v13 offset:8576
    ds_read_b64_tr_b16 v[106:107], v14 offset:8608
    ds_read_b64_tr_b16 v[108:109], v13 offset:8640
    ds_read_b64_tr_b16 v[110:111], v14 offset:8672
    ds_read_b64_tr_b16 v[112:113], v13 offset:8704
    ds_read_b64_tr_b16 v[114:115], v14 offset:8736
    ds_read_b64_tr_b16 v[116:117], v13 offset:8768
    ds_read_b64_tr_b16 v[118:119], v14 offset:8800
    ds_read_b64_tr_b16 v[120:121], v13 offset:8832
    ds_read_b64_tr_b16 v[122:123], v14 offset:8864
    ds_read_b64_tr_b16 v[124:125], v13 offset:8896
    ds_read_b64_tr_b16 v[126:127], v14 offset:8928
    s_waitcnt lgkmcnt(12)
    v_mfma_f32_16x16x16_bf16 v[32:35], v[200:201], v[96:97], v[32:35]
    v_mfma_f32_16x16x16_bf16 v[36:39], v[200:201], v[98:99], v[36:39]
    v_mfma_f32_16x16x16_bf16 v[40:43], v[200:201], v[100:101], v[40:43]
    v_mfma_f32_16x16x16_bf16 v[44:47], v[200:201], v[102:103], v[44:47]
    s_waitcnt lgkmcnt(8)
    v_mfma_f32_16x16x16_bf16 v[48:51], v[200:201], v[104:105], v[48:51]
    v_mfma_f32_16x16x16_bf16 v[52:55], v[200:201], v[106:107], v[52:55]
    v_mfma_f32_16x16x16_bf16 v[56:59], v[200:201], v[108:109], v[56:59]
    v_mfma_f32_16x16x16_bf16 v[60:63], v[200:201], v[110:111], v[60:63]
    s_waitcnt lgkmcnt(4)
    v_mfma_f32_16x16x16_bf16 v[64:67], v[200:201], v[112:113], v[64:67]
    v_mfma_f32_16x16x16_bf16 v[68:71], v[200:201], v[114:115], v[68:71]
    v_mfma_f32_16x16x16_bf16 v[72:75], v[200:201], v[116:117], v[72:75]
    v_mfma_f32_16x16x16_bf16 v[76:79], v[200:201], v[118:119], v[76:79]
    s_waitcnt lgkmcnt(0)
    v_mfma_f32_16x16x16_bf16 v[80:83], v[200:201], v[120:121], v[80:83]
    v_mfma_f32_16x16x16_bf16 v[84:87], v[200:201], v[122:123], v[84:87]
    v_mfma_f32_16x16x16_bf16 v[88:91], v[200:201], v[124:125], v[88:91]
    v_mfma_f32_16x16x16_bf16 v[92:95], v[200:201], v[126:127], v[92:95]
    s_waitcnt vmcnt(25)
    s_add_u32 m0, s61, 4224
    s_add_u32 s60, s7, 212992
    buffer_load_dwordx4 v3, s[16:19], s60 offen nt lds
    s_add_u32 m0, s61, 31680
    s_add_u32 s60, s63, 93184
    buffer_load_dwordx4 v6, s[24:27], s60 offen lds
    ds_read_b64_tr_b16 a[98:99], v11 offset:33792
    ds_read_b64_tr_b16 a[102:103], v11 offset:33824
    ds_read_b64_tr_b16 a[106:107], v11 offset:33856
    ds_read_b64_tr_b16 a[110:111], v11 offset:33888
    ds_read_b64_tr_b16 a[114:115], v12 offset:33920
    ds_read_b64_tr_b16 a[118:119], v12 offset:33952
    ds_read_b64_tr_b16 a[122:123], v12 offset:33984
    ds_read_b64_tr_b16 a[126:127], v12 offset:34016
    s_waitcnt lgkmcnt(0)
    s_waitcnt vmcnt(26)
    s_add_u32 m0, s61, 5280
    s_add_u32 s60, s7, 214016
    buffer_load_dwordx4 v3, s[16:19], s60 offen nt lds
    s_waitcnt vmcnt(25)
    s_add_u32 m0, s61, 6336
    s_add_u32 s60, s7, 215040
    buffer_load_dwordx4 v3, s[16:19], s60 offen nt lds
    s_add_u32 m0, s61, 32736
    s_add_u32 s60, s63, 107520
    buffer_load_dwordx4 v6, s[24:27], s60 offen lds
    s_waitcnt vmcnt(26)
    s_add_u32 m0, s61, 7392
    s_add_u32 s60, s7, 216064
    buffer_load_dwordx4 v3, s[16:19], s60 offen nt lds
    s_waitcnt vmcnt(25)
    s_add_u32 m0, s61, 8448
    s_add_u32 s60, s7, 229376
    buffer_load_dwordx4 v3, s[16:19], s60 offen nt lds
    s_add_u32 m0, s61, 33792
    s_add_u32 s60, s63, 7168
    buffer_load_dwordx4 v6, s[24:27], s60 offen lds
    s_waitcnt vmcnt(18)
    s_add_u32 m0, s61, 9504
    s_add_u32 s60, s7, 230400
    buffer_load_dwordx4 v3, s[16:19], s60 offen nt lds
    s_waitcnt vmcnt(17)
    s_add_u32 m0, s61, 10560
    s_add_u32 s60, s7, 231424
    buffer_load_dwordx4 v3, s[16:19], s60 offen nt lds
    s_add_u32 m0, s61, 34848
    s_add_u32 s60, s63, 21504
    buffer_load_dwordx4 v6, s[24:27], s60 offen lds
    s_waitcnt vmcnt(18)
    s_add_u32 m0, s61, 11616
    s_add_u32 s60, s7, 232448
    buffer_load_dwordx4 v3, s[16:19], s60 offen nt lds
    ds_read_b64_tr_b16 v[96:97], v13 offset:16896
    ds_read_b64_tr_b16 v[98:99], v14 offset:16928
    ds_read_b64_tr_b16 v[100:101], v13 offset:16960
    ds_read_b64_tr_b16 v[102:103], v14 offset:16992
    ds_read_b64_tr_b16 v[104:105], v13 offset:17024
    ds_read_b64_tr_b16 v[106:107], v14 offset:17056
    ds_read_b64_tr_b16 v[108:109], v13 offset:17088
    ds_read_b64_tr_b16 v[110:111], v14 offset:17120
    ds_read_b64_tr_b16 v[112:113], v13 offset:17152
    ds_read_b64_tr_b16 v[114:115], v14 offset:17184
    ds_read_b64_tr_b16 v[116:117], v13 offset:17216
    ds_read_b64_tr_b16 v[118:119], v14 offset:17248
    ds_read_b64_tr_b16 v[120:121], v13 offset:17280
    ds_read_b64_tr_b16 v[122:123], v14 offset:17312
    ds_read_b64_tr_b16 v[124:125], v13 offset:17344
    ds_read_b64_tr_b16 v[126:127], v14 offset:17376
    s_waitcnt lgkmcnt(12)
    v_mfma_f32_16x16x16_bf16 v[32:35], v[202:203], v[96:97], v[32:35]
    v_mfma_f32_16x16x16_bf16 v[36:39], v[202:203], v[98:99], v[36:39]
    v_mfma_f32_16x16x16_bf16 v[40:43], v[202:203], v[100:101], v[40:43]
    v_mfma_f32_16x16x16_bf16 v[44:47], v[202:203], v[102:103], v[44:47]
    s_waitcnt lgkmcnt(8)
    v_mfma_f32_16x16x16_bf16 v[48:51], v[202:203], v[104:105], v[48:51]
    v_mfma_f32_16x16x16_bf16 v[52:55], v[202:203], v[106:107], v[52:55]
    v_mfma_f32_16x16x16_bf16 v[56:59], v[202:203], v[108:109], v[56:59]
    v_mfma_f32_16x16x16_bf16 v[60:63], v[202:203], v[110:111], v[60:63]
    s_waitcnt lgkmcnt(4)
    v_mfma_f32_16x16x16_bf16 v[64:67], v[202:203], v[112:113], v[64:67]
    v_mfma_f32_16x16x16_bf16 v[68:71], v[202:203], v[114:115], v[68:71]
    v_mfma_f32_16x16x16_bf16 v[72:75], v[202:203], v[116:117], v[72:75]
    v_mfma_f32_16x16x16_bf16 v[76:79], v[202:203], v[118:119], v[76:79]
    s_waitcnt lgkmcnt(0)
    v_mfma_f32_16x16x16_bf16 v[80:83], v[202:203], v[120:121], v[80:83]
    v_mfma_f32_16x16x16_bf16 v[84:87], v[202:203], v[122:123], v[84:87]
    v_mfma_f32_16x16x16_bf16 v[88:91], v[202:203], v[124:125], v[88:91]
    v_mfma_f32_16x16x16_bf16 v[92:95], v[202:203], v[126:127], v[92:95]
    s_waitcnt vmcnt(17)
    s_add_u32 m0, s61, 12672
    s_add_u32 s60, s7, 245760
    buffer_load_dwordx4 v3, s[16:19], s60 offen nt lds
    s_add_u32 m0, s61, 35904
    s_add_u32 s60, s63, 35840
    buffer_load_dwordx4 v6, s[24:27], s60 offen lds
    ds_read_b64_tr_b16 a[96:97], v11 offset:25344
    ds_read_b64_tr_b16 a[100:101], v11 offset:25376
    ds_read_b64_tr_b16 a[104:105], v11 offset:25408
    ds_read_b64_tr_b16 a[108:109], v11 offset:25440
    ds_read_b64_tr_b16 a[112:113], v12 offset:25472
    ds_read_b64_tr_b16 a[116:117], v12 offset:25504
    ds_read_b64_tr_b16 a[120:121], v12 offset:25536
    ds_read_b64_tr_b16 a[124:125], v12 offset:25568
    s_waitcnt lgkmcnt(0)
    s_waitcnt vmcnt(18)
    s_add_u32 m0, s61, 13728
    s_add_u32 s60, s7, 246784
    buffer_load_dwordx4 v3, s[16:19], s60 offen nt lds
    s_waitcnt vmcnt(17)
    s_add_u32 m0, s61, 14784
    s_add_u32 s60, s7, 247808
    buffer_load_dwordx4 v3, s[16:19], s60 offen nt lds
    s_add_u32 m0, s61, 36960
    s_add_u32 s60, s63, 50176
    buffer_load_dwordx4 v6, s[24:27], s60 offen lds
    s_waitcnt vmcnt(18)
    s_add_u32 m0, s61, 15840
    s_add_u32 s60, s7, 248832
    buffer_load_dwordx4 v3, s[16:19], s60 offen nt lds
    s_waitcnt vmcnt(17)
    s_add_u32 m0, s61, 16896
    s_add_u32 s60, s7, 262144
    buffer_load_dwordx4 v3, s[16:19], s60 offen nt lds
    s_add_u32 m0, s61, 25344
    s_add_u32 s60, s63, 60928
    buffer_load_dwordx4 v6, s[24:27], s60 offen lds
    s_waitcnt vmcnt(17)
    s_add_u32 m0, s61, 17952
    s_add_u32 s60, s7, 263168
    buffer_load_dwordx4 v3, s[16:19], s60 offen nt lds
    s_waitcnt vmcnt(17)
    s_add_u32 m0, s61, 19008
    s_add_u32 s60, s7, 264192
    buffer_load_dwordx4 v3, s[16:19], s60 offen nt lds
    s_add_u32 m0, s61, 26400
    s_add_u32 s60, s63, 75264
    buffer_load_dwordx4 v6, s[24:27], s60 offen lds
    s_waitcnt vmcnt(17)
    s_add_u32 m0, s61, 20064
    s_add_u32 s60, s7, 265216
    buffer_load_dwordx4 v3, s[16:19], s60 offen nt lds
    ds_read_b64_tr_b16 a[66:67], v11 offset:29568
    ds_read_b64_tr_b16 a[70:71], v11 offset:29600
    ds_read_b64_tr_b16 a[74:75], v11 offset:29632
    ds_read_b64_tr_b16 a[78:79], v11 offset:29664
    ds_read_b64_tr_b16 a[82:83], v12 offset:29696
    ds_read_b64_tr_b16 a[86:87], v12 offset:29728
    ds_read_b64_tr_b16 a[90:91], v12 offset:29760
    ds_read_b64_tr_b16 a[94:95], v12 offset:29792
    s_waitcnt lgkmcnt(0)
    ds_read_b64_tr_b16 v[96:97], v13 offset:0
    ds_read_b64_tr_b16 v[98:99], v14 offset:32
    ds_read_b64_tr_b16 v[100:101], v13 offset:64
    ds_read_b64_tr_b16 v[102:103], v14 offset:96
    ds_read_b64_tr_b16 v[104:105], v13 offset:128
    ds_read_b64_tr_b16 v[106:107], v14 offset:160
    ds_read_b64_tr_b16 v[108:109], v13 offset:192
    ds_read_b64_tr_b16 v[110:111], v14 offset:224
    ds_read_b64_tr_b16 v[112:113], v13 offset:256
    ds_read_b64_tr_b16 v[114:115], v14 offset:288
    ds_read_b64_tr_b16 v[116:117], v13 offset:320
    ds_read_b64_tr_b16 v[118:119], v14 offset:352
    ds_read_b64_tr_b16 v[120:121], v13 offset:384
    ds_read_b64_tr_b16 v[122:123], v14 offset:416
    ds_read_b64_tr_b16 v[124:125], v13 offset:448
    ds_read_b64_tr_b16 v[126:127], v14 offset:480
    s_waitcnt lgkmcnt(12)
    v_mfma_f32_16x16x16_bf16 v[32:35], v[204:205], v[96:97], v[32:35]
    v_mfma_f32_16x16x16_bf16 v[36:39], v[204:205], v[98:99], v[36:39]
    v_mfma_f32_16x16x16_bf16 v[40:43], v[204:205], v[100:101], v[40:43]
    v_mfma_f32_16x16x16_bf16 v[44:47], v[204:205], v[102:103], v[44:47]
    s_waitcnt lgkmcnt(8)
    v_mfma_f32_16x16x16_bf16 v[48:51], v[204:205], v[104:105], v[48:51]
    v_mfma_f32_16x16x16_bf16 v[52:55], v[204:205], v[106:107], v[52:55]
    v_mfma_f32_16x16x16_bf16 v[56:59], v[204:205], v[108:109], v[56:59]
    v_mfma_f32_16x16x16_bf16 v[60:63], v[204:205], v[110:111], v[60:63]
    s_waitcnt lgkmcnt(4)
    v_mfma_f32_16x16x16_bf16 v[64:67], v[204:205], v[112:113], v[64:67]
    v_mfma_f32_16x16x16_bf16 v[68:71], v[204:205], v[114:115], v[68:71]
    v_mfma_f32_16x16x16_bf16 v[72:75], v[204:205], v[116:117], v[72:75]
    v_mfma_f32_16x16x16_bf16 v[76:79], v[204:205], v[118:119], v[76:79]
    s_waitcnt lgkmcnt(0)
    v_mfma_f32_16x16x16_bf16 v[80:83], v[204:205], v[120:121], v[80:83]
    v_mfma_f32_16x16x16_bf16 v[84:87], v[204:205], v[122:123], v[84:87]
    v_mfma_f32_16x16x16_bf16 v[88:91], v[204:205], v[124:125], v[88:91]
    v_mfma_f32_16x16x16_bf16 v[92:95], v[204:205], v[126:127], v[92:95]
    s_waitcnt vmcnt(17)
    s_add_u32 m0, s61, 21120
    s_add_u32 s60, s7, 278528
    buffer_load_dwordx4 v3, s[16:19], s60 offen nt lds
    s_add_u32 m0, s61, 27456
    s_add_u32 s60, s63, 89600
    buffer_load_dwordx4 v6, s[24:27], s60 offen lds
    s_waitcnt vmcnt(17)
    s_add_u32 m0, s61, 22176
    s_add_u32 s60, s7, 279552
    buffer_load_dwordx4 v3, s[16:19], s60 offen nt lds
    s_waitcnt vmcnt(17)
    s_add_u32 m0, s61, 23232
    s_add_u32 s60, s7, 280576
    buffer_load_dwordx4 v3, s[16:19], s60 offen nt lds
    s_add_u32 m0, s61, 28512
    s_add_u32 s60, s63, 103936
    buffer_load_dwordx4 v6, s[24:27], s60 offen lds
    s_waitcnt vmcnt(17)
    s_add_u32 m0, s61, 24288
    s_add_u32 s60, s7, 281600
    buffer_load_dwordx4 v3, s[16:19], s60 offen nt lds
    s_waitcnt vmcnt(17)
    s_add_u32 m0, s61, 0
    s_add_u32 s60, s7, 294912
    buffer_load_dwordx4 v3, s[16:19], s60 offen nt lds
    s_add_u32 m0, s61, 29568
    s_add_u32 s60, s63, 3584
    buffer_load_dwordx4 v6, s[24:27], s60 offen lds
    s_waitcnt vmcnt(17)
    s_add_u32 m0, s61, 1056
    s_add_u32 s60, s7, 295936
    buffer_load_dwordx4 v3, s[16:19], s60 offen nt lds
    s_waitcnt vmcnt(17)
    s_add_u32 m0, s61, 2112
    s_add_u32 s60, s7, 296960
    buffer_load_dwordx4 v3, s[16:19], s60 offen nt lds
    s_add_u32 m0, s61, 30624
    s_add_u32 s60, s63, 17920
    buffer_load_dwordx4 v6, s[24:27], s60 offen lds
    s_waitcnt vmcnt(17)
    s_add_u32 m0, s61, 3168
    s_add_u32 s60, s7, 297984
    buffer_load_dwordx4 v3, s[16:19], s60 offen nt lds
    s_add_u32 m0, s61, 31680
    s_add_u32 s60, s63, 32256
    buffer_load_dwordx4 v6, s[24:27], s60 offen lds
    ds_read_b64_tr_b16 a[64:65], v11 offset:33792
    ds_read_b64_tr_b16 a[68:69], v11 offset:33824
    ds_read_b64_tr_b16 a[72:73], v11 offset:33856
    ds_read_b64_tr_b16 a[76:77], v11 offset:33888
    ds_read_b64_tr_b16 a[80:81], v12 offset:33920
    ds_read_b64_tr_b16 a[84:85], v12 offset:33952
    ds_read_b64_tr_b16 a[88:89], v12 offset:33984
    ds_read_b64_tr_b16 a[92:93], v12 offset:34016
    s_waitcnt lgkmcnt(0)
    ds_read_b64_tr_b16 v[96:97], v13 offset:8448
    ds_read_b64_tr_b16 v[98:99], v14 offset:8480
    ds_read_b64_tr_b16 v[100:101], v13 offset:8512
    ds_read_b64_tr_b16 v[102:103], v14 offset:8544
    ds_read_b64_tr_b16 v[104:105], v13 offset:8576
    ds_read_b64_tr_b16 v[106:107], v14 offset:8608
    ds_read_b64_tr_b16 v[108:109], v13 offset:8640
    ds_read_b64_tr_b16 v[110:111], v14 offset:8672
    ds_read_b64_tr_b16 v[112:113], v13 offset:8704
    ds_read_b64_tr_b16 v[114:115], v14 offset:8736
    ds_read_b64_tr_b16 v[116:117], v13 offset:8768
    ds_read_b64_tr_b16 v[118:119], v14 offset:8800
    ds_read_b64_tr_b16 v[120:121], v13 offset:8832
    ds_read_b64_tr_b16 v[122:123], v14 offset:8864
    ds_read_b64_tr_b16 v[124:125], v13 offset:8896
    ds_read_b64_tr_b16 v[126:127], v14 offset:8928
    s_waitcnt lgkmcnt(12)
    v_mfma_f32_16x16x16_bf16 v[32:35], v[206:207], v[96:97], v[32:35]
    v_mfma_f32_16x16x16_bf16 v[36:39], v[206:207], v[98:99], v[36:39]
    v_mfma_f32_16x16x16_bf16 v[40:43], v[206:207], v[100:101], v[40:43]
    v_mfma_f32_16x16x16_bf16 v[44:47], v[206:207], v[102:103], v[44:47]
    s_waitcnt lgkmcnt(8)
    v_mfma_f32_16x16x16_bf16 v[48:51], v[206:207], v[104:105], v[48:51]
    v_mfma_f32_16x16x16_bf16 v[52:55], v[206:207], v[106:107], v[52:55]
    v_mfma_f32_16x16x16_bf16 v[56:59], v[206:207], v[108:109], v[56:59]
    v_mfma_f32_16x16x16_bf16 v[60:63], v[206:207], v[110:111], v[60:63]
    s_waitcnt lgkmcnt(4)
    v_mfma_f32_16x16x16_bf16 v[64:67], v[206:207], v[112:113], v[64:67]
    v_mfma_f32_16x16x16_bf16 v[68:71], v[206:207], v[114:115], v[68:71]
    v_mfma_f32_16x16x16_bf16 v[72:75], v[206:207], v[116:117], v[72:75]
    v_mfma_f32_16x16x16_bf16 v[76:79], v[206:207], v[118:119], v[76:79]
    s_waitcnt lgkmcnt(0)
    v_mfma_f32_16x16x16_bf16 v[80:83], v[206:207], v[120:121], v[80:83]
    v_mfma_f32_16x16x16_bf16 v[84:87], v[206:207], v[122:123], v[84:87]
    v_mfma_f32_16x16x16_bf16 v[88:91], v[206:207], v[124:125], v[88:91]
    v_mfma_f32_16x16x16_bf16 v[92:95], v[206:207], v[126:127], v[92:95]
    s_waitcnt vmcnt(18)
    s_add_u32 m0, s61, 4224
    s_add_u32 s60, s7, 311296
    buffer_load_dwordx4 v3, s[16:19], s60 offen nt lds
    s_waitcnt vmcnt(17)
    s_add_u32 m0, s61, 5280
    s_add_u32 s60, s7, 312320
    buffer_load_dwordx4 v3, s[16:19], s60 offen nt lds
    s_add_u32 m0, s61, 32736
    s_add_u32 s60, s63, 46592
    buffer_load_dwordx4 v6, s[24:27], s60 offen lds
    s_waitcnt vmcnt(18)
    s_add_u32 m0, s61, 6336
    s_add_u32 s60, s7, 313344
    buffer_load_dwordx4 v3, s[16:19], s60 offen nt lds
    s_waitcnt vmcnt(17)
    s_add_u32 m0, s61, 7392
    s_add_u32 s60, s7, 314368
    buffer_load_dwordx4 v3, s[16:19], s60 offen nt lds
    s_add_u32 m0, s61, 33792
    s_add_u32 s60, s63, 57344
    buffer_load_dwordx4 v6, s[24:27], s60 offen lds
    s_waitcnt vmcnt(18)
    s_add_u32 m0, s61, 8448
    s_add_u32 s60, s7, 327680
    buffer_load_dwordx4 v3, s[16:19], s60 offen nt lds
    s_waitcnt vmcnt(17)
    s_add_u32 m0, s61, 9504
    s_add_u32 s60, s7, 328704
    buffer_load_dwordx4 v3, s[16:19], s60 offen nt lds
    s_add_u32 m0, s61, 34848
    s_add_u32 s60, s63, 71680
    buffer_load_dwordx4 v6, s[24:27], s60 offen lds
    s_waitcnt vmcnt(18)
    s_add_u32 m0, s61, 10560
    s_add_u32 s60, s7, 329728
    buffer_load_dwordx4 v3, s[16:19], s60 offen nt lds
    s_waitcnt vmcnt(17)
    s_add_u32 m0, s61, 11616
    s_add_u32 s60, s7, 330752
    buffer_load_dwordx4 v3, s[16:19], s60 offen nt lds
    s_add_u32 m0, s61, 35904
    s_add_u32 s60, s63, 86016
    buffer_load_dwordx4 v6, s[24:27], s60 offen lds
    ds_read_b64_tr_b16 a[34:35], v11 offset:25344
    ds_read_b64_tr_b16 a[38:39], v11 offset:25376
    ds_read_b64_tr_b16 a[42:43], v11 offset:25408
    ds_read_b64_tr_b16 a[46:47], v11 offset:25440
    ds_read_b64_tr_b16 a[50:51], v12 offset:25472
    ds_read_b64_tr_b16 a[54:55], v12 offset:25504
    ds_read_b64_tr_b16 a[58:59], v12 offset:25536
    ds_read_b64_tr_b16 a[62:63], v12 offset:25568
    s_waitcnt lgkmcnt(0)
    ds_read_b64_tr_b16 v[96:97], v13 offset:16896
    ds_read_b64_tr_b16 v[98:99], v14 offset:16928
    ds_read_b64_tr_b16 v[100:101], v13 offset:16960
    ds_read_b64_tr_b16 v[102:103], v14 offset:16992
    ds_read_b64_tr_b16 v[104:105], v13 offset:17024
    ds_read_b64_tr_b16 v[106:107], v14 offset:17056
    ds_read_b64_tr_b16 v[108:109], v13 offset:17088
    ds_read_b64_tr_b16 v[110:111], v14 offset:17120
    ds_read_b64_tr_b16 v[112:113], v13 offset:17152
    ds_read_b64_tr_b16 v[114:115], v14 offset:17184
    ds_read_b64_tr_b16 v[116:117], v13 offset:17216
    ds_read_b64_tr_b16 v[118:119], v14 offset:17248
    ds_read_b64_tr_b16 v[120:121], v13 offset:17280
    ds_read_b64_tr_b16 v[122:123], v14 offset:17312
    ds_read_b64_tr_b16 v[124:125], v13 offset:17344
    ds_read_b64_tr_b16 v[126:127], v14 offset:17376
    s_waitcnt lgkmcnt(12)
    v_mfma_f32_16x16x16_bf16 v[32:35], v[208:209], v[96:97], v[32:35]
    v_mfma_f32_16x16x16_bf16 v[36:39], v[208:209], v[98:99], v[36:39]
    v_mfma_f32_16x16x16_bf16 v[40:43], v[208:209], v[100:101], v[40:43]
    v_mfma_f32_16x16x16_bf16 v[44:47], v[208:209], v[102:103], v[44:47]
    s_waitcnt lgkmcnt(8)
    v_mfma_f32_16x16x16_bf16 v[48:51], v[208:209], v[104:105], v[48:51]
    v_mfma_f32_16x16x16_bf16 v[52:55], v[208:209], v[106:107], v[52:55]
    v_mfma_f32_16x16x16_bf16 v[56:59], v[208:209], v[108:109], v[56:59]
    v_mfma_f32_16x16x16_bf16 v[60:63], v[208:209], v[110:111], v[60:63]
    s_waitcnt lgkmcnt(4)
    v_mfma_f32_16x16x16_bf16 v[64:67], v[208:209], v[112:113], v[64:67]
    v_mfma_f32_16x16x16_bf16 v[68:71], v[208:209], v[114:115], v[68:71]
    v_mfma_f32_16x16x16_bf16 v[72:75], v[208:209], v[116:117], v[72:75]
    v_mfma_f32_16x16x16_bf16 v[76:79], v[208:209], v[118:119], v[76:79]
    s_waitcnt lgkmcnt(0)
    v_mfma_f32_16x16x16_bf16 v[80:83], v[208:209], v[120:121], v[80:83]
    v_mfma_f32_16x16x16_bf16 v[84:87], v[208:209], v[122:123], v[84:87]
    v_mfma_f32_16x16x16_bf16 v[88:91], v[208:209], v[124:125], v[88:91]
    v_mfma_f32_16x16x16_bf16 v[92:95], v[208:209], v[126:127], v[92:95]
    s_waitcnt vmcnt(18)
    s_add_u32 m0, s61, 12672
    s_add_u32 s60, s7, 344064
    buffer_load_dwordx4 v3, s[16:19], s60 offen nt lds
    s_waitcnt vmcnt(17)
    s_add_u32 m0, s61, 13728
    s_add_u32 s60, s7, 345088
    buffer_load_dwordx4 v3, s[16:19], s60 offen nt lds
    s_add_u32 m0, s61, 36960
    s_add_u32 s60, s63, 100352
    buffer_load_dwordx4 v6, s[24:27], s60 offen lds
    s_waitcnt vmcnt(18)
    s_add_u32 m0, s61, 14784
    s_add_u32 s60, s7, 346112
    buffer_load_dwordx4 v3, s[16:19], s60 offen nt lds
    s_waitcnt vmcnt(17)
    s_add_u32 m0, s61, 15840
    s_add_u32 s60, s7, 347136
    buffer_load_dwordx4 v3, s[16:19], s60 offen nt lds
    s_add_u32 m0, s61, 25344
    s_add_u32 s60, s63, 0
    buffer_load_dwordx4 v6, s[24:27], s60 offen lds
    s_waitcnt vmcnt(17)
    s_add_u32 m0, s61, 16896
    s_add_u32 s60, s7, 360448
    buffer_load_dwordx4 v3, s[16:19], s60 offen nt lds
    s_waitcnt vmcnt(17)
    s_add_u32 m0, s61, 17952
    s_add_u32 s60, s7, 361472
    buffer_load_dwordx4 v3, s[16:19], s60 offen nt lds
    s_add_u32 m0, s61, 26400
    s_add_u32 s60, s63, 14336
    buffer_load_dwordx4 v6, s[24:27], s60 offen lds
    s_waitcnt vmcnt(17)
    s_add_u32 m0, s61, 19008
    s_add_u32 s60, s7, 362496
    buffer_load_dwordx4 v3, s[16:19], s60 offen nt lds
    ds_read_b64_tr_b16 a[32:33], v11 offset:29568
    ds_read_b64_tr_b16 a[36:37], v11 offset:29600
    ds_read_b64_tr_b16 a[40:41], v11 offset:29632
    ds_read_b64_tr_b16 a[44:45], v11 offset:29664
    ds_read_b64_tr_b16 a[48:49], v12 offset:29696
    ds_read_b64_tr_b16 a[52:53], v12 offset:29728
    ds_read_b64_tr_b16 a[56:57], v12 offset:29760
    ds_read_b64_tr_b16 a[60:61], v12 offset:29792
    s_waitcnt lgkmcnt(0)
    s_waitcnt vmcnt(17)
    s_add_u32 m0, s61, 20064
    s_add_u32 s60, s7, 363520
    buffer_load_dwordx4 v3, s[16:19], s60 offen nt lds
    s_add_u32 m0, s61, 27456
    s_add_u32 s60, s63, 28672
    buffer_load_dwordx4 v6, s[24:27], s60 offen lds
    ds_read_b64_tr_b16 v[96:97], v13 offset:0
    ds_read_b64_tr_b16 v[98:99], v14 offset:32
    ds_read_b64_tr_b16 v[100:101], v13 offset:64
    ds_read_b64_tr_b16 v[102:103], v14 offset:96
    ds_read_b64_tr_b16 v[104:105], v13 offset:128
    ds_read_b64_tr_b16 v[106:107], v14 offset:160
    ds_read_b64_tr_b16 v[108:109], v13 offset:192
    ds_read_b64_tr_b16 v[110:111], v14 offset:224
    ds_read_b64_tr_b16 v[112:113], v13 offset:256
    ds_read_b64_tr_b16 v[114:115], v14 offset:288
    ds_read_b64_tr_b16 v[116:117], v13 offset:320
    ds_read_b64_tr_b16 v[118:119], v14 offset:352
    ds_read_b64_tr_b16 v[120:121], v13 offset:384
    ds_read_b64_tr_b16 v[122:123], v14 offset:416
    ds_read_b64_tr_b16 v[124:125], v13 offset:448
    ds_read_b64_tr_b16 v[126:127], v14 offset:480
    s_waitcnt lgkmcnt(12)
    v_mfma_f32_16x16x16_bf16 v[32:35], v[210:211], v[96:97], v[32:35]
    v_mfma_f32_16x16x16_bf16 v[36:39], v[210:211], v[98:99], v[36:39]
    v_mfma_f32_16x16x16_bf16 v[40:43], v[210:211], v[100:101], v[40:43]
    v_mfma_f32_16x16x16_bf16 v[44:47], v[210:211], v[102:103], v[44:47]
    s_waitcnt lgkmcnt(8)
    v_mfma_f32_16x16x16_bf16 v[48:51], v[210:211], v[104:105], v[48:51]
    v_mfma_f32_16x16x16_bf16 v[52:55], v[210:211], v[106:107], v[52:55]
    v_mfma_f32_16x16x16_bf16 v[56:59], v[210:211], v[108:109], v[56:59]
    v_mfma_f32_16x16x16_bf16 v[60:63], v[210:211], v[110:111], v[60:63]
    s_waitcnt lgkmcnt(4)
    v_mfma_f32_16x16x16_bf16 v[64:67], v[210:211], v[112:113], v[64:67]
    v_mfma_f32_16x16x16_bf16 v[68:71], v[210:211], v[114:115], v[68:71]
    v_mfma_f32_16x16x16_bf16 v[72:75], v[210:211], v[116:117], v[72:75]
    v_mfma_f32_16x16x16_bf16 v[76:79], v[210:211], v[118:119], v[76:79]
    s_waitcnt lgkmcnt(0)
    v_mfma_f32_16x16x16_bf16 v[80:83], v[210:211], v[120:121], v[80:83]
    v_mfma_f32_16x16x16_bf16 v[84:87], v[210:211], v[122:123], v[84:87]
    v_mfma_f32_16x16x16_bf16 v[88:91], v[210:211], v[124:125], v[88:91]
    v_mfma_f32_16x16x16_bf16 v[92:95], v[210:211], v[126:127], v[92:95]
    s_waitcnt vmcnt(17)
    s_add_u32 m0, s61, 21120
    s_add_u32 s60, s7, 376832
    buffer_load_dwordx4 v3, s[16:19], s60 offen nt lds
    s_waitcnt vmcnt(17)
    s_add_u32 m0, s61, 22176
    s_add_u32 s60, s7, 377856
    buffer_load_dwordx4 v3, s[16:19], s60 offen nt lds
    s_add_u32 m0, s61, 28512
    s_add_u32 s60, s63, 43008
    buffer_load_dwordx4 v6, s[24:27], s60 offen lds
    s_waitcnt vmcnt(17)
    s_add_u32 m0, s61, 23232
    s_add_u32 s60, s7, 378880
    buffer_load_dwordx4 v3, s[16:19], s60 offen nt lds
    s_waitcnt vmcnt(17)
    s_add_u32 m0, s61, 24288
    s_add_u32 s60, s7, 379904
    buffer_load_dwordx4 v3, s[16:19], s60 offen nt lds
    s_add_u32 m0, s61, 29568
    s_add_u32 s60, s63, 179200
    buffer_load_dwordx4 v6, s[24:27], s60 offen lds
    s_waitcnt vmcnt(17)
    s_add_u32 m0, s61, 0
    s_add_u32 s60, s7, 393216
    buffer_load_dwordx4 v3, s[16:19], s60 offen nt lds
    v_lshrrev_b32 v7, 2, v1
    v_lshlrev_b32 v7, 3, v7
    v_bfe_u32 v20, v1, 4, 1
    v_bfe_u32 v21, v1, 5, 1
    v_lshl_add_u32 v20, v20, 1, v21
    s_and_b32 s90, s2, 7
    s_lshl_b32 s90, s90, 6
    s_lshl_b32 s91, s3, 2
    s_add_u32 s90, s90, s91
    s_bfe_u32 s91, s2, 0x20003
    s_mul_i32 s91, s91, 448
    s_add_u32 s90, s90, s91
    v_and_b32 v21, 15, v1
    v_lshl_add_u32 v9, v20, 4, v21
    v_add_u32 v9, s90, v9
    v_lshlrev_b32 v9, 1, v9
    v_cmp_gt_u32 vcc, 4, v21
    v_bfrev_b32 v20, 1
    s_nop 0
    v_cndmask_b32 v9, v20, v9, vcc
    buffer_load_dwordx2 v[160:161], v7, s[48:51], s97 offen offset:0 sc1
    buffer_load_dwordx2 v[162:163], v7, s[48:51], s97 offen offset:128 sc1
    buffer_load_dwordx2 v[164:165], v7, s[48:51], s97 offen offset:256 sc1
    buffer_load_dwordx2 v[166:167], v7, s[48:51], s97 offen offset:384 sc1
    buffer_load_dwordx4 v[128:131], v16, s[48:51], s96 offen offset:0 sc1
    buffer_load_dwordx4 v[132:135], v16, s[48:51], s96 offen offset:1024 sc1
    buffer_load_dwordx4 v[136:139], v16, s[48:51], s96 offen offset:2048 sc1
    buffer_load_dwordx4 v[140:143], v16, s[48:51], s96 offen offset:3072 sc1
    buffer_load_ushort v176, v9, s[8:11], 0 offen
    s_mul_i32 s90, s3, 576
    v_add_u32 v8, s90, v16
    v_and_b32 v20, 3, v1
    v_mul_u32_u24 v10, 576, v20
    v_lshrrev_b32 v20, 4, v1
    v_lshl_add_u32 v10, v20, 4, v10
    s_add_u32 s91, s92, 16384
    s_waitcnt vmcnt(26)
    s_add_u32 m0, s61, 1056
    s_add_u32 s60, s7, 394240
    buffer_load_dwordx4 v3, s[16:19], s60 offen nt lds
    s_add_u32 m0, s61, 30624
    s_add_u32 s60, s63, 193536
    buffer_load_dwordx4 v6, s[24:27], s60 offen lds
    s_waitcnt vmcnt(26)
    s_add_u32 m0, s61, 2112
    s_add_u32 s60, s7, 395264
    buffer_load_dwordx4 v3, s[16:19], s60 offen nt lds
    s_add_u32 m0, s61, 31680
    s_add_u32 s60, s63, 207872
    buffer_load_dwordx4 v6, s[24:27], s60 offen lds
    ds_read_b64_tr_b16 a[2:3], v11 offset:33792
    ds_read_b64_tr_b16 a[6:7], v11 offset:33824
    ds_read_b64_tr_b16 a[10:11], v11 offset:33856
    ds_read_b64_tr_b16 a[14:15], v11 offset:33888
    ds_read_b64_tr_b16 a[18:19], v12 offset:33920
    ds_read_b64_tr_b16 a[22:23], v12 offset:33952
    ds_read_b64_tr_b16 a[26:27], v12 offset:33984
    ds_read_b64_tr_b16 a[30:31], v12 offset:34016
    s_waitcnt lgkmcnt(0)
    s_waitcnt vmcnt(27)
    s_add_u32 m0, s61, 3168
    s_add_u32 s60, s7, 396288
    buffer_load_dwordx4 v3, s[16:19], s60 offen nt lds
    ds_read_b64_tr_b16 v[96:97], v13 offset:8448
    ds_read_b64_tr_b16 v[98:99], v14 offset:8480
    ds_read_b64_tr_b16 v[100:101], v13 offset:8512
    ds_read_b64_tr_b16 v[102:103], v14 offset:8544
    ds_read_b64_tr_b16 v[104:105], v13 offset:8576
    ds_read_b64_tr_b16 v[106:107], v14 offset:8608
    ds_read_b64_tr_b16 v[108:109], v13 offset:8640
    ds_read_b64_tr_b16 v[110:111], v14 offset:8672
    ds_read_b64_tr_b16 v[112:113], v13 offset:8704
    ds_read_b64_tr_b16 v[114:115], v14 offset:8736
    ds_read_b64_tr_b16 v[116:117], v13 offset:8768
    ds_read_b64_tr_b16 v[118:119], v14 offset:8800
    ds_read_b64_tr_b16 v[120:121], v13 offset:8832
    ds_read_b64_tr_b16 v[122:123], v14 offset:8864
    ds_read_b64_tr_b16 v[124:125], v13 offset:8896
    ds_read_b64_tr_b16 v[126:127], v14 offset:8928
    s_waitcnt lgkmcnt(12)
    v_mfma_f32_16x16x16_bf16 v[32:35], v[212:213], v[96:97], v[32:35]
    v_mfma_f32_16x16x16_bf16 v[36:39], v[212:213], v[98:99], v[36:39]
    v_mfma_f32_16x16x16_bf16 v[40:43], v[212:213], v[100:101], v[40:43]
    v_mfma_f32_16x16x16_bf16 v[44:47], v[212:213], v[102:103], v[44:47]
    s_waitcnt lgkmcnt(8)
    v_mfma_f32_16x16x16_bf16 v[48:51], v[212:213], v[104:105], v[48:51]
    v_mfma_f32_16x16x16_bf16 v[52:55], v[212:213], v[106:107], v[52:55]
    v_mfma_f32_16x16x16_bf16 v[56:59], v[212:213], v[108:109], v[56:59]
    v_mfma_f32_16x16x16_bf16 v[60:63], v[212:213], v[110:111], v[60:63]
    s_waitcnt lgkmcnt(4)
    v_mfma_f32_16x16x16_bf16 v[64:67], v[212:213], v[112:113], v[64:67]
    v_mfma_f32_16x16x16_bf16 v[68:71], v[212:213], v[114:115], v[68:71]
    v_mfma_f32_16x16x16_bf16 v[72:75], v[212:213], v[116:117], v[72:75]
    v_mfma_f32_16x16x16_bf16 v[76:79], v[212:213], v[118:119], v[76:79]
    s_waitcnt lgkmcnt(0)
    v_mfma_f32_16x16x16_bf16 v[80:83], v[212:213], v[120:121], v[80:83]
    v_mfma_f32_16x16x16_bf16 v[84:87], v[212:213], v[122:123], v[84:87]
    v_mfma_f32_16x16x16_bf16 v[88:91], v[212:213], v[124:125], v[88:91]
    v_mfma_f32_16x16x16_bf16 v[92:95], v[212:213], v[126:127], v[92:95]
    s_waitcnt vmcnt(26)
    s_add_u32 m0, s61, 4224
    s_add_u32 s60, s7, 409600
    buffer_load_dwordx4 v3, s[16:19], s60 offen nt lds
    s_add_u32 m0, s61, 32736
    s_add_u32 s60, s63, 222208
    buffer_load_dwordx4 v6, s[24:27], s60 offen lds
    s_waitcnt vmcnt(27)
    s_add_u32 m0, s61, 5280
    s_add_u32 s60, s7, 410624
    buffer_load_dwordx4 v3, s[16:19], s60 offen nt lds
    s_waitcnt vmcnt(26)
    s_add_u32 m0, s61, 6336
    s_add_u32 s60, s7, 411648
    buffer_load_dwordx4 v3, s[16:19], s60 offen nt lds
    s_add_u32 m0, s61, 33792
    s_add_u32 s60, s63, 121856
    buffer_load_dwordx4 v6, s[24:27], s60 offen lds
    s_waitcnt vmcnt(27)
    s_add_u32 m0, s61, 7392
    s_add_u32 s60, s7, 412672
    buffer_load_dwordx4 v3, s[16:19], s60 offen nt lds
    s_waitcnt vmcnt(26)
    s_add_u32 m0, s61, 8448
    s_add_u32 s60, s7, 425984
    buffer_load_dwordx4 v3, s[16:19], s60 offen nt lds
    s_add_u32 m0, s61, 34848
    s_add_u32 s60, s63, 136192
    buffer_load_dwordx4 v6, s[24:27], s60 offen lds
    s_waitcnt vmcnt(27)
    s_add_u32 m0, s61, 9504
    s_add_u32 s60, s7, 427008
    buffer_load_dwordx4 v3, s[16:19], s60 offen nt lds
    s_waitcnt vmcnt(26)
    s_add_u32 m0, s61, 10560
    s_add_u32 s60, s7, 428032
    buffer_load_dwordx4 v3, s[16:19], s60 offen nt lds
    s_add_u32 m0, s61, 35904
    s_add_u32 s60, s63, 150528
    buffer_load_dwordx4 v6, s[24:27], s60 offen lds
    ds_read_b64_tr_b16 a[0:1], v11 offset:25344
    ds_read_b64_tr_b16 a[4:5], v11 offset:25376
    ds_read_b64_tr_b16 a[8:9], v11 offset:25408
    ds_read_b64_tr_b16 a[12:13], v11 offset:25440
    ds_read_b64_tr_b16 a[16:17], v12 offset:25472
    ds_read_b64_tr_b16 a[20:21], v12 offset:25504
    ds_read_b64_tr_b16 a[24:25], v12 offset:25536
    ds_read_b64_tr_b16 a[28:29], v12 offset:25568
    s_waitcnt lgkmcnt(0)
    s_waitcnt vmcnt(27)
    s_add_u32 m0, s61, 11616
    s_add_u32 s60, s7, 429056
    buffer_load_dwordx4 v3, s[16:19], s60 offen nt lds
    ds_read_b64_tr_b16 v[96:97], v13 offset:16896
    ds_read_b64_tr_b16 v[98:99], v14 offset:16928
    ds_read_b64_tr_b16 v[100:101], v13 offset:16960
    ds_read_b64_tr_b16 v[102:103], v14 offset:16992
    ds_read_b64_tr_b16 v[104:105], v13 offset:17024
    ds_read_b64_tr_b16 v[106:107], v14 offset:17056
    ds_read_b64_tr_b16 v[108:109], v13 offset:17088
    ds_read_b64_tr_b16 v[110:111], v14 offset:17120
    ds_read_b64_tr_b16 v[112:113], v13 offset:17152
    ds_read_b64_tr_b16 v[114:115], v14 offset:17184
    ds_read_b64_tr_b16 v[116:117], v13 offset:17216
    ds_read_b64_tr_b16 v[118:119], v14 offset:17248
    ds_read_b64_tr_b16 v[120:121], v13 offset:17280
    ds_read_b64_tr_b16 v[122:123], v14 offset:17312
    ds_read_b64_tr_b16 v[124:125], v13 offset:17344
    ds_read_b64_tr_b16 v[126:127], v14 offset:17376
    s_waitcnt lgkmcnt(12)
    v_mfma_f32_16x16x16_bf16 v[32:35], v[214:215], v[96:97], v[32:35]
    v_mfma_f32_16x16x16_bf16 v[36:39], v[214:215], v[98:99], v[36:39]
    v_mfma_f32_16x16x16_bf16 v[40:43], v[214:215], v[100:101], v[40:43]
    v_mfma_f32_16x16x16_bf16 v[44:47], v[214:215], v[102:103], v[44:47]
    s_waitcnt lgkmcnt(8)
    v_mfma_f32_16x16x16_bf16 v[48:51], v[214:215], v[104:105], v[48:51]
    v_mfma_f32_16x16x16_bf16 v[52:55], v[214:215], v[106:107], v[52:55]
    v_mfma_f32_16x16x16_bf16 v[56:59], v[214:215], v[108:109], v[56:59]
    v_mfma_f32_16x16x16_bf16 v[60:63], v[214:215], v[110:111], v[60:63]
    s_waitcnt lgkmcnt(4)
    v_mfma_f32_16x16x16_bf16 v[64:67], v[214:215], v[112:113], v[64:67]
    v_mfma_f32_16x16x16_bf16 v[68:71], v[214:215], v[114:115], v[68:71]
    v_mfma_f32_16x16x16_bf16 v[72:75], v[214:215], v[116:117], v[72:75]
    v_mfma_f32_16x16x16_bf16 v[76:79], v[214:215], v[118:119], v[76:79]
    s_waitcnt lgkmcnt(0)
    v_mfma_f32_16x16x16_bf16 v[80:83], v[214:215], v[120:121], v[80:83]
    v_mfma_f32_16x16x16_bf16 v[84:87], v[214:215], v[122:123], v[84:87]
    v_mfma_f32_16x16x16_bf16 v[88:91], v[214:215], v[124:125], v[88:91]
    v_mfma_f32_16x16x16_bf16 v[92:95], v[214:215], v[126:127], v[92:95]
    s_waitcnt vmcnt(26)
    s_add_u32 m0, s61, 12672
    s_add_u32 s60, s7, 442368
    buffer_load_dwordx4 v3, s[16:19], s60 offen nt lds
    s_add_u32 m0, s61, 36960
    s_add_u32 s60, s63, 164864
    buffer_load_dwordx4 v6, s[24:27], s60 offen lds
    s_waitcnt vmcnt(18)
    s_add_u32 m0, s61, 13728
    s_add_u32 s60, s7, 443392
    buffer_load_dwordx4 v3, s[16:19], s60 offen nt lds
    s_waitcnt vmcnt(17)
    s_add_u32 m0, s61, 14784
    s_add_u32 s60, s7, 444416
    buffer_load_dwordx4 v3, s[16:19], s60 offen nt lds
    s_waitcnt vmcnt(16)
    s_add_u32 m0, s61, 15840
    s_add_u32 s60, s7, 445440
    buffer_load_dwordx4 v3, s[16:19], s60 offen nt lds
    s_waitcnt vmcnt(16)
    s_add_u32 m0, s61, 16896
    s_add_u32 s60, s7, 458752
    buffer_load_dwordx4 v3, s[16:19], s60 offen nt lds
    s_cmp_ge_u32 s99, 32
    s_cbranch_scc1 L_pre_done
    s_mov_b32 s93, 262144
L_pre:
    v_max_f32_dpp v20, v160, v160 row_ror:4 row_mask:0xf bank_mask:0xf
    s_nop 1
    v_max_f32_dpp v20, v20, v20 row_ror:8 row_mask:0xf bank_mask:0xf
    v_sub_f32 v20, v160, v20
    v_exp_f32 v20, v20
    s_nop 0
    v_mul_f32 v21, v20, v161
    s_nop 1
    v_add_f32_dpp v21, v21, v21 row_ror:4 row_mask:0xf bank_mask:0xf
    s_nop 1
    v_add_f32_dpp v21, v21, v21 row_ror:8 row_mask:0xf bank_mask:0xf
    v_rcp_f32 v21, v21
    s_nop 0
    v_mul_f32 v178, v20, v21
    v_max_f32_dpp v20, v162, v162 row_ror:4 row_mask:0xf bank_mask:0xf
    s_nop 1
    v_max_f32_dpp v20, v20, v20 row_ror:8 row_mask:0xf bank_mask:0xf
    v_sub_f32 v20, v162, v20
    v_exp_f32 v20, v20
    s_nop 0
    v_mul_f32 v21, v20, v163
    s_nop 1
    v_add_f32_dpp v21, v21, v21 row_ror:4 row_mask:0xf bank_mask:0xf
    s_nop 1
    v_add_f32_dpp v21, v21, v21 row_ror:8 row_mask:0xf bank_mask:0xf
    v_rcp_f32 v21, v21
    s_nop 0
    v_mul_f32 v179, v20, v21
    v_max_f32_dpp v20, v164, v164 row_ror:4 row_mask:0xf bank_mask:0xf
    s_nop 1
    v_max_f32_dpp v20, v20, v20 row_ror:8 row_mask:0xf bank_mask:0xf
    v_sub_f32 v20, v164, v20
    v_exp_f32 v20, v20
    s_nop 0
    v_mul_f32 v21, v20, v165
    s_nop 1
    v_add_f32_dpp v21, v21, v21 row_ror:4 row_mask:0xf bank_mask:0xf
    s_nop 1
    v_add_f32_dpp v21, v21, v21 row_ror:8 row_mask:0xf bank_mask:0xf
    v_rcp_f32 v21, v21
    s_nop 0
    v_mul_f32 v180, v20, v21
    v_max_f32_dpp v20, v166, v166 row_ror:4 row_mask:0xf bank_mask:0xf
    s_nop 1
    v_max_f32_dpp v20, v20, v20 row_ror:8 row_mask:0xf bank_mask:0xf
    v_sub_f32 v20, v166, v20
    v_exp_f32 v20, v20
    s_nop 0
    v_mul_f32 v21, v20, v167
    s_nop 1
    v_add_f32_dpp v21, v21, v21 row_ror:4 row_mask:0xf bank_mask:0xf
    s_nop 1
    v_add_f32_dpp v21, v21, v21 row_ror:8 row_mask:0xf bank_mask:0xf
    v_rcp_f32 v21, v21
    s_nop 0
    v_mul_f32 v181, v20, v21
    v_add_f32 v24, v128, v132
    v_add_f32 v28, v136, v140
    v_add_f32 v25, v129, v133
    v_add_f32 v29, v137, v141
    v_add_f32 v26, v130, v134
    v_add_f32 v30, v138, v142
    v_add_f32 v27, v131, v135
    v_add_f32 v31, v139, v143
    v_add_f32 v24, v24, v28
    v_add_f32 v25, v25, v29
    v_add_f32 v26, v26, v30
    v_add_f32 v27, v27, v31
    v_permlane32_swap_b32 v24, v25
    s_nop 0
    v_permlane32_swap_b32 v26, v27
    v_add_f32 v24, v24, v25
    v_add_f32 v26, v26, v27
    s_nop 1
    v_permlane16_swap_b32 v24, v26
    v_add_f32 v24, v24, v26
    s_nop 1
    v_add_f32_dpp v24, v24, v24 row_ror:4 row_mask:0xf bank_mask:0xf
    s_nop 1
    v_add_f32_dpp v24, v24, v24 row_ror:8 row_mask:0xf bank_mask:0xf
    v_add_f32 v20, v178, v179
    v_add_f32 v21, v180, v181
    v_add_f32 v20, v20, v21
    v_cmp_u_f32 vcc, v20, v24
    s_nop 0
    s_cmp_eq_u64 vcc, 0
    s_cbranch_scc1 L_pre_ok
    s_sub_u32 s93, s93, 1
    s_cbranch_scc1 L_pre_ok
    buffer_load_dwordx2 v[160:161], v7, s[48:51], s97 offen offset:0 sc1
    buffer_load_dwordx2 v[162:163], v7, s[48:51], s97 offen offset:128 sc1
    buffer_load_dwordx2 v[164:165], v7, s[48:51], s97 offen offset:256 sc1
    buffer_load_dwordx2 v[166:167], v7, s[48:51], s97 offen offset:384 sc1
    buffer_load_dwordx4 v[128:131], v16, s[48:51], s96 offen offset:0 sc1
    buffer_load_dwordx4 v[132:135], v16, s[48:51], s96 offen offset:1024 sc1
    buffer_load_dwordx4 v[136:139], v16, s[48:51], s96 offen offset:2048 sc1
    buffer_load_dwordx4 v[140:143], v16, s[48:51], s96 offen offset:3072 sc1
    s_waitcnt vmcnt(0)
    s_branch L_pre
L_pre_ok:
    v_cvt_pk_bf16_f32 v24, v24, v24
    v_and_b32 v24, 0xffff0000, v24
    v_mul_f32 v20, 0xbfb8aa3b, v24
    v_exp_f32 v20, v20
    s_nop 0
    v_add_f32 v20, 1.0, v20
    v_rcp_f32 v20, v20
    s_nop 0
    v_mul_f32 v182, v24, v20
    v_cvt_pk_bf16_f32 v182, v182, v182
    v_and_b32 v182, 0xffff0000, v182
    v_lshlrev_b32 v176, 16, v176
L_pre_done:
    s_nop 1
    s_waitcnt vmcnt(15)
    s_add_u32 m0, s61, 17952
    s_add_u32 s60, s7, 459776
    buffer_load_dwordx4 v3, s[16:19], s60 offen nt lds
    ds_read_b64_tr_b16 a[194:195], v11 offset:29568
    ds_read_b64_tr_b16 a[198:199], v11 offset:29600
    ds_read_b64_tr_b16 a[202:203], v11 offset:29632
    ds_read_b64_tr_b16 a[206:207], v11 offset:29664
    ds_read_b64_tr_b16 a[210:211], v12 offset:29696
    ds_read_b64_tr_b16 a[214:215], v12 offset:29728
    ds_read_b64_tr_b16 a[218:219], v12 offset:29760
    ds_read_b64_tr_b16 a[222:223], v12 offset:29792
    s_waitcnt lgkmcnt(0)
    s_waitcnt vmcnt(15)
    s_add_u32 m0, s61, 19008
    s_add_u32 s60, s7, 460800
    buffer_load_dwordx4 v3, s[16:19], s60 offen nt lds
    s_waitcnt vmcnt(14)
    s_add_u32 m0, s61, 20064
    s_add_u32 s60, s7, 461824
    buffer_load_dwordx4 v3, s[16:19], s60 offen nt lds
    ds_read_b64_tr_b16 v[96:97], v13 offset:0
    ds_read_b64_tr_b16 v[98:99], v14 offset:32
    ds_read_b64_tr_b16 v[100:101], v13 offset:64
    ds_read_b64_tr_b16 v[102:103], v14 offset:96
    ds_read_b64_tr_b16 v[104:105], v13 offset:128
    ds_read_b64_tr_b16 v[106:107], v14 offset:160
    ds_read_b64_tr_b16 v[108:109], v13 offset:192
    ds_read_b64_tr_b16 v[110:111], v14 offset:224
    ds_read_b64_tr_b16 v[112:113], v13 offset:256
    ds_read_b64_tr_b16 v[114:115], v14 offset:288
    ds_read_b64_tr_b16 v[116:117], v13 offset:320
    ds_read_b64_tr_b16 v[118:119], v14 offset:352
    ds_read_b64_tr_b16 v[120:121], v13 offset:384
    ds_read_b64_tr_b16 v[122:123], v14 offset:416
    ds_read_b64_tr_b16 v[124:125], v13 offset:448
    ds_read_b64_tr_b16 v[126:127], v14 offset:480
    v_mul_f32 v32, s6, v32
    v_mul_f32 v36, s6, v36
    v_mul_f32 v40, s6, v40
    v_mul_f32 v44, s6, v44
    v_mul_f32 v48, s6, v48
    v_mul_f32 v52, s6, v52
    v_mul_f32 v56, s6, v56
    v_mul_f32 v60, s6, v60
    v_mul_f32 v64, s6, v64
    v_mul_f32 v68, s6, v68
    v_mul_f32 v72, s6, v72
    v_mul_f32 v76, s6, v76
    v_mul_f32 v80, s6, v80
    v_mul_f32 v84, s6, v84
    v_mul_f32 v88, s6, v88
    v_mul_f32 v92, s6, v92
    s_waitcnt lgkmcnt(12)
    v_mfma_f32_16x16x16_bf16 v[32:35], v[216:217], v[96:97], v[32:35]
    v_mfma_f32_16x16x16_bf16 v[36:39], v[216:217], v[98:99], v[36:39]
    v_mfma_f32_16x16x16_bf16 v[40:43], v[216:217], v[100:101], v[40:43]
    v_mfma_f32_16x16x16_bf16 v[44:47], v[216:217], v[102:103], v[44:47]
    s_waitcnt lgkmcnt(8)
    v_mfma_f32_16x16x16_bf16 v[48:51], v[216:217], v[104:105], v[48:51]
    v_mfma_f32_16x16x16_bf16 v[52:55], v[216:217], v[106:107], v[52:55]
    v_mfma_f32_16x16x16_bf16 v[56:59], v[216:217], v[108:109], v[56:59]
    v_mfma_f32_16x16x16_bf16 v[60:63], v[216:217], v[110:111], v[60:63]
    s_waitcnt lgkmcnt(4)
    v_mfma_f32_16x16x16_bf16 v[64:67], v[216:217], v[112:113], v[64:67]
    v_mfma_f32_16x16x16_bf16 v[68:71], v[216:217], v[114:115], v[68:71]
    v_mfma_f32_16x16x16_bf16 v[72:75], v[216:217], v[116:117], v[72:75]
    v_mfma_f32_16x16x16_bf16 v[76:79], v[216:217], v[118:119], v[76:79]
    s_waitcnt lgkmcnt(0)
    v_mfma_f32_16x16x16_bf16 v[80:83], v[216:217], v[120:121], v[80:83]
    v_mfma_f32_16x16x16_bf16 v[84:87], v[216:217], v[122:123], v[84:87]
    v_mfma_f32_16x16x16_bf16 v[88:91], v[216:217], v[124:125], v[88:91]
    v_mfma_f32_16x16x16_bf16 v[92:95], v[216:217], v[126:127], v[92:95]
    s_waitcnt vmcnt(14)
    s_add_u32 m0, s61, 21120
    s_add_u32 s60, s7, 475136
    buffer_load_dwordx4 v3, s[16:19], s60 offen nt lds
    s_waitcnt vmcnt(13)
    s_add_u32 m0, s61, 22176
    s_add_u32 s60, s7, 476160
    buffer_load_dwordx4 v3, s[16:19], s60 offen nt lds
    s_waitcnt vmcnt(13)
    s_add_u32 m0, s61, 23232
    s_add_u32 s60, s7, 477184
    buffer_load_dwordx4 v3, s[16:19], s60 offen nt lds
    s_waitcnt vmcnt(12)
    s_add_u32 m0, s61, 24288
    s_add_u32 s60, s7, 478208
    buffer_load_dwordx4 v3, s[16:19], s60 offen nt lds
    s_waitcnt vmcnt(12)
    s_add_u32 m0, s61, 0
    s_add_u32 s60, s7, 491520
    buffer_load_dwordx4 v3, s[16:19], s60 offen nt lds
    s_waitcnt vmcnt(11)
    s_add_u32 m0, s61, 1056
    s_add_u32 s60, s7, 492544
    buffer_load_dwordx4 v3, s[16:19], s60 offen nt lds
    ds_read_b64_tr_b16 a[192:193], v11 offset:33792
    ds_read_b64_tr_b16 a[196:197], v11 offset:33824
    ds_read_b64_tr_b16 a[200:201], v11 offset:33856
    ds_read_b64_tr_b16 a[204:205], v11 offset:33888
    ds_read_b64_tr_b16 a[208:209], v12 offset:33920
    ds_read_b64_tr_b16 a[212:213], v12 offset:33952
    ds_read_b64_tr_b16 a[216:217], v12 offset:33984
    ds_read_b64_tr_b16 a[220:221], v12 offset:34016
    s_waitcnt lgkmcnt(0)
    s_waitcnt vmcnt(11)
    s_add_u32 m0, s61, 2112
    s_add_u32 s60, s7, 493568
    buffer_load_dwordx4 v3, s[16:19], s60 offen nt lds
    s_waitcnt vmcnt(11)
    s_add_u32 m0, s61, 3168
    s_add_u32 s60, s7, 494592
    buffer_load_dwordx4 v3, s[16:19], s60 offen nt lds
    ds_read_b64_tr_b16 v[96:97], v13 offset:8448
    ds_read_b64_tr_b16 v[98:99], v14 offset:8480
    ds_read_b64_tr_b16 v[100:101], v13 offset:8512
    ds_read_b64_tr_b16 v[102:103], v14 offset:8544
    ds_read_b64_tr_b16 v[104:105], v13 offset:8576
    ds_read_b64_tr_b16 v[106:107], v14 offset:8608
    ds_read_b64_tr_b16 v[108:109], v13 offset:8640
    ds_read_b64_tr_b16 v[110:111], v14 offset:8672
    ds_read_b64_tr_b16 v[112:113], v13 offset:8704
    ds_read_b64_tr_b16 v[114:115], v14 offset:8736
    ds_read_b64_tr_b16 v[116:117], v13 offset:8768
    ds_read_b64_tr_b16 v[118:119], v14 offset:8800
    ds_read_b64_tr_b16 v[120:121], v13 offset:8832
    ds_read_b64_tr_b16 v[122:123], v14 offset:8864
    ds_read_b64_tr_b16 v[124:125], v13 offset:8896
    ds_read_b64_tr_b16 v[126:127], v14 offset:8928
    s_waitcnt lgkmcnt(12)
    v_mfma_f32_16x16x16_bf16 v[32:35], v[218:219], v[96:97], v[32:35]
    v_mfma_f32_16x16x16_bf16 v[36:39], v[218:219], v[98:99], v[36:39]
    v_mfma_f32_16x16x16_bf16 v[40:43], v[218:219], v[100:101], v[40:43]
    v_mfma_f32_16x16x16_bf16 v[44:47], v[218:219], v[102:103], v[44:47]
    s_waitcnt lgkmcnt(8)
    v_mfma_f32_16x16x16_bf16 v[48:51], v[218:219], v[104:105], v[48:51]
    v_mfma_f32_16x16x16_bf16 v[52:55], v[218:219], v[106:107], v[52:55]
    v_mfma_f32_16x16x16_bf16 v[56:59], v[218:219], v[108:109], v[56:59]
    v_mfma_f32_16x16x16_bf16 v[60:63], v[218:219], v[110:111], v[60:63]
    s_waitcnt lgkmcnt(4)
    v_mfma_f32_16x16x16_bf16 v[64:67], v[218:219], v[112:113], v[64:67]
    v_mfma_f32_16x16x16_bf16 v[68:71], v[218:219], v[114:115], v[68:71]
    v_mfma_f32_16x16x16_bf16 v[72:75], v[218:219], v[116:117], v[72:75]
    v_mfma_f32_16x16x16_bf16 v[76:79], v[218:219], v[118:119], v[76:79]
    s_waitcnt lgkmcnt(0)
    v_mfma_f32_16x16x16_bf16 v[80:83], v[218:219], v[120:121], v[80:83]
    v_mfma_f32_16x16x16_bf16 v[84:87], v[218:219], v[122:123], v[84:87]
    v_mfma_f32_16x16x16_bf16 v[88:91], v[218:219], v[124:125], v[88:91]
    v_mfma_f32_16x16x16_bf16 v[92:95], v[218:219], v[126:127], v[92:95]
    s_waitcnt vmcnt(11)
    s_add_u32 m0, s61, 4224
    s_add_u32 s60, s7, 507904
    buffer_load_dwordx4 v3, s[16:19], s60 offen nt lds
    s_waitcnt vmcnt(11)
    s_add_u32 m0, s61, 5280
    s_add_u32 s60, s7, 508928
    buffer_load_dwordx4 v3, s[16:19], s60 offen nt lds
    s_waitcnt vmcnt(11)
    s_add_u32 m0, s61, 6336
    s_add_u32 s60, s7, 509952
    buffer_load_dwordx4 v3, s[16:19], s60 offen nt lds
    s_waitcnt vmcnt(11)
    s_add_u32 m0, s61, 7392
    s_add_u32 s60, s7, 510976
    buffer_load_dwordx4 v3, s[16:19], s60 offen nt lds
    s_waitcnt vmcnt(11)
    s_waitcnt vmcnt(10)
    s_waitcnt vmcnt(9)
    s_waitcnt vmcnt(8)
    ds_read_b64_tr_b16 v[96:97], v13 offset:16896
    ds_read_b64_tr_b16 v[98:99], v14 offset:16928
    ds_read_b64_tr_b16 v[100:101], v13 offset:16960
    ds_read_b64_tr_b16 v[102:103], v14 offset:16992
    ds_read_b64_tr_b16 v[104:105], v13 offset:17024
    ds_read_b64_tr_b16 v[106:107], v14 offset:17056
    ds_read_b64_tr_b16 v[108:109], v13 offset:17088
    ds_read_b64_tr_b16 v[110:111], v14 offset:17120
    ds_read_b64_tr_b16 v[112:113], v13 offset:17152
    ds_read_b64_tr_b16 v[114:115], v14 offset:17184
    ds_read_b64_tr_b16 v[116:117], v13 offset:17216
    ds_read_b64_tr_b16 v[118:119], v14 offset:17248
    ds_read_b64_tr_b16 v[120:121], v13 offset:17280
    ds_read_b64_tr_b16 v[122:123], v14 offset:17312
    ds_read_b64_tr_b16 v[124:125], v13 offset:17344
    ds_read_b64_tr_b16 v[126:127], v14 offset:17376
    s_waitcnt lgkmcnt(12)
    v_mfma_f32_16x16x16_bf16 v[32:35], v[220:221], v[96:97], v[32:35]
    v_mfma_f32_16x16x16_bf16 v[36:39], v[220:221], v[98:99], v[36:39]
    v_mfma_f32_16x16x16_bf16 v[40:43], v[220:221], v[100:101], v[40:43]
    v_mfma_f32_16x16x16_bf16 v[44:47], v[220:221], v[102:103], v[44:47]
    s_waitcnt lgkmcnt(8)
    v_mfma_f32_16x16x16_bf16 v[48:51], v[220:221], v[104:105], v[48:51]
    v_mfma_f32_16x16x16_bf16 v[52:55], v[220:221], v[106:107], v[52:55]
    v_mfma_f32_16x16x16_bf16 v[56:59], v[220:221], v[108:109], v[56:59]
    v_mfma_f32_16x16x16_bf16 v[60:63], v[220:221], v[110:111], v[60:63]
    s_waitcnt lgkmcnt(4)
    v_mfma_f32_16x16x16_bf16 v[64:67], v[220:221], v[112:113], v[64:67]
    v_mfma_f32_16x16x16_bf16 v[68:71], v[220:221], v[114:115], v[68:71]
    v_mfma_f32_16x16x16_bf16 v[72:75], v[220:221], v[116:117], v[72:75]
    v_mfma_f32_16x16x16_bf16 v[76:79], v[220:221], v[118:119], v[76:79]
    s_waitcnt lgkmcnt(0)
    v_mfma_f32_16x16x16_bf16 v[80:83], v[220:221], v[120:121], v[80:83]
    v_mfma_f32_16x16x16_bf16 v[84:87], v[220:221], v[122:123], v[84:87]
    v_mfma_f32_16x16x16_bf16 v[88:91], v[220:221], v[124:125], v[88:91]
    v_mfma_f32_16x16x16_bf16 v[92:95], v[220:221], v[126:127], v[92:95]
    s_waitcnt vmcnt(7)
    s_waitcnt vmcnt(6)
    s_waitcnt vmcnt(5)
    s_waitcnt vmcnt(4)
    s_waitcnt vmcnt(3)
    s_waitcnt vmcnt(2)
    s_waitcnt vmcnt(1)
    s_waitcnt vmcnt(0)
    ds_read_b64_tr_b16 v[96:97], v13 offset:0
    ds_read_b64_tr_b16 v[98:99], v14 offset:32
    ds_read_b64_tr_b16 v[100:101], v13 offset:64
    ds_read_b64_tr_b16 v[102:103], v14 offset:96
    ds_read_b64_tr_b16 v[104:105], v13 offset:128
    ds_read_b64_tr_b16 v[106:107], v14 offset:160
    ds_read_b64_tr_b16 v[108:109], v13 offset:192
    ds_read_b64_tr_b16 v[110:111], v14 offset:224
    ds_read_b64_tr_b16 v[112:113], v13 offset:256
    ds_read_b64_tr_b16 v[114:115], v14 offset:288
    ds_read_b64_tr_b16 v[116:117], v13 offset:320
    ds_read_b64_tr_b16 v[118:119], v14 offset:352
    ds_read_b64_tr_b16 v[120:121], v13 offset:384
    ds_read_b64_tr_b16 v[122:123], v14 offset:416
    ds_read_b64_tr_b16 v[124:125], v13 offset:448
    ds_read_b64_tr_b16 v[126:127], v14 offset:480
    s_waitcnt lgkmcnt(12)
    v_mfma_f32_16x16x16_bf16 v[32:35], v[222:223], v[96:97], v[32:35]
    v_mfma_f32_16x16x16_bf16 v[36:39], v[222:223], v[98:99], v[36:39]
    v_mfma_f32_16x16x16_bf16 v[40:43], v[222:223], v[100:101], v[40:43]
    v_mfma_f32_16x16x16_bf16 v[44:47], v[222:223], v[102:103], v[44:47]
    s_waitcnt lgkmcnt(8)
    v_mfma_f32_16x16x16_bf16 v[48:51], v[222:223], v[104:105], v[48:51]
    v_mfma_f32_16x16x16_bf16 v[52:55], v[222:223], v[106:107], v[52:55]
    v_mfma_f32_16x16x16_bf16 v[56:59], v[222:223], v[108:109], v[56:59]
    v_mfma_f32_16x16x16_bf16 v[60:63], v[222:223], v[110:111], v[60:63]
    s_waitcnt lgkmcnt(4)
    v_mfma_f32_16x16x16_bf16 v[64:67], v[222:223], v[112:113], v[64:67]
    v_mfma_f32_16x16x16_bf16 v[68:71], v[222:223], v[114:115], v[68:71]
    v_mfma_f32_16x16x16_bf16 v[72:75], v[222:223], v[116:117], v[72:75]
    v_mfma_f32_16x16x16_bf16 v[76:79], v[222:223], v[118:119], v[76:79]
    s_waitcnt lgkmcnt(0)
    v_mfma_f32_16x16x16_bf16 v[80:83], v[222:223], v[120:121], v[80:83]
    v_mfma_f32_16x16x16_bf16 v[84:87], v[222:223], v[122:123], v[84:87]
    v_mfma_f32_16x16x16_bf16 v[88:91], v[222:223], v[124:125], v[88:91]
    v_mfma_f32_16x16x16_bf16 v[92:95], v[222:223], v[126:127], v[92:95]
    v_cvt_pk_bf16_f32 v128, v32, v36
    v_cvt_pk_bf16_f32 v129, v40, v44
    v_cvt_pk_bf16_f32 v130, v48, v52
    v_cvt_pk_bf16_f32 v131, v56, v60
    v_cvt_pk_bf16_f32 v132, v64, v68
    v_cvt_pk_bf16_f32 v133, v72, v76
    v_cvt_pk_bf16_f32 v134, v80, v84
    s_nop 0
    v_cvt_pk_bf16_f32 v135, v88, v92
    s_mov_b64 exec, 0xffff
    ds_write_b128 v8, v[128:131] offset:8512
    ds_write_b128 v8, v[132:135] offset:8768
    s_mov_b64 exec, -1
    s_waitcnt lgkmcnt(0)
    s_barrier
    ds_read_b128 v[96:99], v10 offset:8512
    ds_read_b128 v[100:103], v10 offset:8576
    ds_read_b128 v[104:107], v10 offset:8640
    ds_read_b128 v[108:111], v10 offset:8704
    ds_read_b128 v[112:115], v10 offset:8768
    ds_read_b128 v[116:119], v10 offset:8832
    ds_read_b128 v[120:123], v10 offset:8896
    ds_read_b128 v[124:127], v10 offset:8960
    s_waitcnt lgkmcnt(7)
    v_mfma_f32_16x16x32_bf16 v[224:227], v[96:99], a[0:3], 0
    v_mfma_f32_16x16x32_bf16 v[228:231], v[96:99], a[4:7], 0
    v_mfma_f32_16x16x32_bf16 v[232:235], v[96:99], a[8:11], 0
    v_mfma_f32_16x16x32_bf16 v[236:239], v[96:99], a[12:15], 0
    s_waitcnt lgkmcnt(6)
    v_mfma_f32_16x16x32_bf16 v[224:227], v[100:103], a[32:35], v[224:227]
    v_mfma_f32_16x16x32_bf16 v[228:231], v[100:103], a[36:39], v[228:231]
    v_mfma_f32_16x16x32_bf16 v[232:235], v[100:103], a[40:43], v[232:235]
    v_mfma_f32_16x16x32_bf16 v[236:239], v[100:103], a[44:47], v[236:239]
    s_waitcnt lgkmcnt(5)
    v_mfma_f32_16x16x32_bf16 v[224:227], v[104:107], a[64:67], v[224:227]
    v_mfma_f32_16x16x32_bf16 v[228:231], v[104:107], a[68:71], v[228:231]
    v_mfma_f32_16x16x32_bf16 v[232:235], v[104:107], a[72:75], v[232:235]
    v_mfma_f32_16x16x32_bf16 v[236:239], v[104:107], a[76:79], v[236:239]
    s_waitcnt lgkmcnt(4)
    v_mfma_f32_16x16x32_bf16 v[224:227], v[108:111], a[96:99], v[224:227]
    v_mfma_f32_16x16x32_bf16 v[228:231], v[108:111], a[100:103], v[228:231]
    v_mfma_f32_16x16x32_bf16 v[232:235], v[108:111], a[104:107], v[232:235]
    v_mfma_f32_16x16x32_bf16 v[236:239], v[108:111], a[108:111], v[236:239]
    s_waitcnt lgkmcnt(3)
    v_mfma_f32_16x16x32_bf16 v[224:227], v[112:115], a[128:131], v[224:227]
    v_mfma_f32_16x16x32_bf16 v[228:231], v[112:115], a[132:135], v[228:231]
    v_mfma_f32_16x16x32_bf16 v[232:235], v[112:115], a[136:139], v[232:235]
    v_mfma_f32_16x16x32_bf16 v[236:239], v[112:115], a[140:143], v[236:239]
    s_waitcnt lgkmcnt(2)
    v_mfma_f32_16x16x32_bf16 v[224:227], v[116:119], a[160:163], v[224:227]
    v_mfma_f32_16x16x32_bf16 v[228:231], v[116:119], a[164:167], v[228:231]
    v_mfma_f32_16x16x32_bf16 v[232:235], v[116:119], a[168:171], v[232:235]
    v_mfma_f32_16x16x32_bf16 v[236:239], v[116:119], a[172:175], v[236:239]
    s_waitcnt lgkmcnt(1)
    v_mfma_f32_16x16x32_bf16 v[224:227], v[120:123], a[192:195], v[224:227]
    v_mfma_f32_16x16x32_bf16 v[228:231], v[120:123], a[196:199], v[228:231]
    v_mfma_f32_16x16x32_bf16 v[232:235], v[120:123], a[200:203], v[232:235]
    v_mfma_f32_16x16x32_bf16 v[236:239], v[120:123], a[204:207], v[236:239]
    s_waitcnt lgkmcnt(0)
    v_mfma_f32_16x16x32_bf16 v[224:227], v[124:127], a[224:227], v[224:227]
    v_mfma_f32_16x16x32_bf16 v[228:231], v[124:127], a[228:231], v[228:231]
    v_mfma_f32_16x16x32_bf16 v[232:235], v[124:127], a[232:235], v[232:235]
    v_mfma_f32_16x16x32_bf16 v[236:239], v[124:127], a[236:239], v[236:239]
    v_mfma_f32_16x16x32_bf16 v[240:243], v[96:99], a[16:19], 0
    v_mfma_f32_16x16x32_bf16 v[244:247], v[96:99], a[20:23], 0
    v_mfma_f32_16x16x32_bf16 v[248:251], v[96:99], a[24:27], 0
    v_mfma_f32_16x16x32_bf16 v[252:255], v[96:99], a[28:31], 0
    v_mfma_f32_16x16x32_bf16 v[240:243], v[100:103], a[48:51], v[240:243]
    v_mfma_f32_16x16x32_bf16 v[244:247], v[100:103], a[52:55], v[244:247]
    v_mfma_f32_16x16x32_bf16 v[248:251], v[100:103], a[56:59], v[248:251]
    v_mfma_f32_16x16x32_bf16 v[252:255], v[100:103], a[60:63], v[252:255]
    v_mfma_f32_16x16x32_bf16 v[240:243], v[104:107], a[80:83], v[240:243]
    v_mfma_f32_16x16x32_bf16 v[244:247], v[104:107], a[84:87], v[244:247]
    v_mfma_f32_16x16x32_bf16 v[248:251], v[104:107], a[88:91], v[248:251]
    v_mfma_f32_16x16x32_bf16 v[252:255], v[104:107], a[92:95], v[252:255]
    v_pk_add_f32 v[224:225], v[224:225], v[226:227]
    v_pk_add_f32 v[228:229], v[228:229], v[230:231]
    v_pk_add_f32 v[232:233], v[232:233], v[234:235]
    v_pk_add_f32 v[236:237], v[236:237], v[238:239]
    v_mfma_f32_16x16x32_bf16 v[240:243], v[108:111], a[112:115], v[240:243]
    v_mfma_f32_16x16x32_bf16 v[244:247], v[108:111], a[116:119], v[244:247]
    v_mfma_f32_16x16x32_bf16 v[248:251], v[108:111], a[120:123], v[248:251]
    v_mfma_f32_16x16x32_bf16 v[252:255], v[108:111], a[124:127], v[252:255]
    v_add_f32 v24, v224, v225
    v_add_f32 v25, v228, v229
    v_add_f32 v26, v232, v233
    v_add_f32 v27, v236, v237
    s_mov_b64 exec, 0xffff
    buffer_store_dwordx4 v[24:27], v4, s[44:47], s92 offen sc1
    s_mov_b64 exec, -1
    v_mfma_f32_16x16x32_bf16 v[240:243], v[112:115], a[144:147], v[240:243]
    v_mfma_f32_16x16x32_bf16 v[244:247], v[112:115], a[148:151], v[244:247]
    v_mfma_f32_16x16x32_bf16 v[248:251], v[112:115], a[152:155], v[248:251]
    v_mfma_f32_16x16x32_bf16 v[252:255], v[112:115], a[156:159], v[252:255]
    v_mfma_f32_16x16x32_bf16 v[240:243], v[116:119], a[176:179], v[240:243]
    v_mfma_f32_16x16x32_bf16 v[244:247], v[116:119], a[180:183], v[244:247]
    v_mfma_f32_16x16x32_bf16 v[248:251], v[116:119], a[184:187], v[248:251]
    v_mfma_f32_16x16x32_bf16 v[252:255], v[116:119], a[188:191], v[252:255]
    v_mfma_f32_16x16x32_bf16 v[240:243], v[120:123], a[208:211], v[240:243]
    v_mfma_f32_16x16x32_bf16 v[244:247], v[120:123], a[212:215], v[244:247]
    v_mfma_f32_16x16x32_bf16 v[248:251], v[120:123], a[216:219], v[248:251]
    v_mfma_f32_16x16x32_bf16 v[252:255], v[120:123], a[220:223], v[252:255]
    v_mfma_f32_16x16x32_bf16 v[240:243], v[124:127], a[240:243], v[240:243]
    v_mfma_f32_16x16x32_bf16 v[244:247], v[124:127], a[244:247], v[244:247]
    v_mfma_f32_16x16x32_bf16 v[248:251], v[124:127], a[248:251], v[248:251]
    v_mfma_f32_16x16x32_bf16 v[252:255], v[124:127], a[252:255], v[252:255]
    s_nop 4
    v_pk_add_f32 v[240:241], v[240:241], v[242:243]
    v_pk_add_f32 v[244:245], v[244:245], v[246:247]
    v_pk_add_f32 v[248:249], v[248:249], v[250:251]
    v_pk_add_f32 v[252:253], v[252:253], v[254:255]
    v_add_f32 v28, v240, v241
    v_add_f32 v29, v244, v245
    v_add_f32 v30, v248, v249
    v_add_f32 v31, v252, v253
    s_mov_b64 exec, 0xffff
    buffer_store_dwordx4 v[28:31], v4, s[44:47], s91 offen sc1
    s_mov_b64 exec, -1
    s_cmp_ge_u32 s99, 32
    s_cbranch_scc1 L_fin
    s_mov_b32 s93, 262144
L_poll:
    buffer_load_dwordx4 v[128:131], v16, s[48:51], s95 offen offset:0 sc1
    buffer_load_dwordx4 v[132:135], v16, s[48:51], s95 offen offset:1024 sc1
    buffer_load_dwordx4 v[136:139], v16, s[48:51], s95 offen offset:2048 sc1
    buffer_load_dwordx4 v[140:143], v16, s[48:51], s95 offen offset:3072 sc1
    s_waitcnt vmcnt(3)
    v_mul_f32 v144, v178, v128
    v_mul_f32 v145, v178, v129
    v_mul_f32 v146, v178, v130
    v_mul_f32 v147, v178, v131
    s_waitcnt vmcnt(2)
    v_fmac_f32 v144, v179, v132
    v_fmac_f32 v145, v179, v133
    v_fmac_f32 v146, v179, v134
    v_fmac_f32 v147, v179, v135
    s_waitcnt vmcnt(1)
    v_fmac_f32 v144, v180, v136
    v_fmac_f32 v145, v180, v137
    v_fmac_f32 v146, v180, v138
    v_fmac_f32 v147, v180, v139
    s_waitcnt vmcnt(0)
    v_fmac_f32 v144, v181, v140
    v_fmac_f32 v145, v181, v141
    v_fmac_f32 v146, v181, v142
    v_fmac_f32 v147, v181, v143
    v_permlane32_swap_b32 v144, v145
    s_nop 0
    v_permlane32_swap_b32 v146, v147
    v_add_f32 v144, v144, v145
    v_add_f32 v146, v146, v147
    s_nop 1
    v_permlane16_swap_b32 v144, v146
    v_add_f32 v144, v144, v146
    s_nop 1
    v_add_f32_dpp v144, v144, v144 row_ror:4 row_mask:0xf bank_mask:0xf
    s_nop 1
    v_add_f32_dpp v144, v144, v144 row_ror:8 row_mask:0xf bank_mask:0xf
    v_cmp_u_f32 vcc, v144, v144
    s_nop 0
    s_cmp_eq_u64 vcc, 0
    s_cbranch_scc1 L_poll_ok
    s_sub_u32 s93, s93, 1
    s_cbranch_scc0 L_poll
L_poll_ok:
    v_cvt_pk_bf16_f32 v144, v144, v144
    v_and_b32 v144, 0xffff0000, v144
    v_mul_f32 v144, v144, v182
    v_cvt_pk_bf16_f32 v144, v144, v144
    v_and_b32 v144, 0xffff0000, v144
    v_add_f32 v144, v144, v176
    v_cvt_pk_bf16_f32 v144, v144, v144
    buffer_store_short v144, v9, s[36:39], 0 offen
L_fin:
L_end:
    s_endpgm
.section .rodata,"a"
.p2align 6
.amdhsa_kernel recurrent_scan__mha_block_cached__glu_gated_bilinear__decode_kernel
  .amdhsa_next_free_vgpr 512
  .amdhsa_next_free_sgpr 102
  .amdhsa_accum_offset 256
  .amdhsa_group_segment_fixed_size 0
  .amdhsa_kernarg_size 96
  .amdhsa_user_sgpr_count 2
  .amdhsa_user_sgpr_kernarg_segment_ptr 1
  .amdhsa_system_sgpr_workgroup_id_x 1
  .amdhsa_float_denorm_mode_32 3
.end_amdhsa_kernel
```
